```python
import torch

def _softmax(x, axis=-1):
    return torch.softmax(x, dim=axis)
def _gelu(x):
    return torch.nn.functional.gelu(x, approximate="tanh")
def _silu(x):
    return torch.nn.functional.silu(x)
def _sigmoid(x):
    return torch.sigmoid(x)
def _layernorm(x, axis=-1, eps=1e-5):
    m = x.mean(dim=axis, keepdim=True)
    v = x.var(dim=axis, keepdim=True, unbiased=False)
    return (x - m) / torch.sqrt(v + eps)
def _scatter_add(tgt, idx, src, axis=0):
    return tgt.clone().index_add_(axis, idx, src)
def _segment_sum(src, seg, n):
    out = torch.zeros((n,) + src.shape[1:], dtype=src.dtype)
    return out.index_add_(0, seg, src)
def _pad(x, pw):
    flat = tuple(v for pair in reversed(pw) for v in pair)
    return torch.nn.functional.pad(x, flat)

kernel_name = 'standalone__mha_block_cached__near_ridge'

def setup_inputs():

    _w = (lambda a: (lambda t: t.to(torch.bfloat16) if t.is_floating_point() else t)(torch.as_tensor(a)))
    B, Sq, D = 16, 32, 640
    H, Sk, Dh = 32, 32, 192
    return {
        "x": _w((lambda *s: torch.randn(*s, dtype=torch.bfloat16) * 0.8)(B, Sq, D)),
        "k_cache": _w((lambda *s: torch.randn(*s, dtype=torch.bfloat16) * 0.8)(B, H, Sk, Dh)),
        "v_cache": _w((lambda *s: torch.randn(*s, dtype=torch.bfloat16) * 0.05)(B, H, Sk, Dh)),
        "wq": _w((lambda *s: torch.randn(*s, dtype=torch.bfloat16) * 0.8)(D, H * Dh) * (D ** -0.5)),
        "wo": _w((lambda *s: torch.randn(*s, dtype=torch.bfloat16) * 0.05)(H * Dh, D) * ((H * Dh) ** -0.5)),
    }

def reference(x, k_cache, v_cache, wq, wo):
    B, Sq, D = x.shape
    H, Dh = 32, 192
    q = (lambda x, *d: x.permute(*d))((x @ wq).reshape(B, Sq, H, Dh), 0, 2, 1, 3)
    scores = torch.einsum("bhqd,bhkd->bhqk", q, k_cache) * (Dh ** -0.5)
    p = _softmax(scores, axis=-1)
    o = torch.einsum("bhqk,bhkd->bhqd", p, v_cache)
    return (lambda x, *d: x.permute(*d))(o, 0, 2, 1, 3).reshape(B, Sq, H * Dh) @ wo
```

```asm
; @launch grid=(256,1,1) block=(256,1,1) lds=163840
.amdgcn_target "amdgcn-amd-amdhsa--gfx950"
.text
.globl standalone__mha_block_cached__near_ridge_kernel
.p2align 8
.type standalone__mha_block_cached__near_ridge_kernel,@function
standalone__mha_block_cached__near_ridge_kernel:
    s_cmp_ge_u32 s2, 256
    s_cbranch_scc1 .Lend
    s_load_dwordx16 s[4:19], s[0:1], 0
    v_readfirstlane_b32 s48, v0
    v_and_b32 v1, 63, v0
    v_lshrrev_b32 v33, 3, v1
    v_and_b32 v34, 7, v1
    v_lshrrev_b32 v35, 4, v1
    s_lshr_b32 s48, s48, 6
    s_and_b32 s64, s2, 7
    s_bfe_u32 s65, s2, 0x20003
    s_bfe_u32 s66, s2, 0x20005
    v_xor_b32 v36, v34, v35
    v_lshlrev_b32 v36, 4, v36
    v_and_b32 v35, 1, v35
    v_lshlrev_b32 v35, 2, v35
    v_xor_b32 v35, v35, v34
    v_lshlrev_b32 v35, 4, v35
    s_lshl_b32 s67, s66, 2
    s_add_u32 s67, s67, s48
    s_xor_b32 s50, s65, s66
    s_mul_i32 s49, s48, 40960
    v_mul_u32_u24 v2, 384, v33
    v_add_u32 v2, v2, v36
    v_xor_b32 v3, 64, v2
    v_add_u32 v4, 4096, v2
    v_add_u32 v5, 6144, v3
    v_add_u32 v3, 2048, v3
    s_mov_b32 m0, s49
    s_mov_b32 s23, 0x20000
    s_mov_b32 s27, 0x20000
    s_lshl_b32 s61, s64, 2
    s_lshl_b32 s62, s67, 5
    s_add_u32 s62, s62, s61
    s_cmp_ge_u32 s2, 128
    s_cbranch_scc1 .LB
.LA1:
    s_add_u32 s61, s61, s65
    s_add_u32 s62, s62, s65
    s_mul_i32 s28, s62, 12288
    v_mul_u32_u24 v6, 1280, v33
    v_mul_u32_u24 v12, 12288, v33
    v_add_u32 v6, v6, v36
    v_add_u32 v12, v12, v35
    s_mul_i32 s20, s67, 40960
    s_mul_i32 s24, s61, 384
    v_xor_b32 v7, 64, v6
    v_add_u32 v8, 18432, v6
    s_mul_i32 s63, s48, 98304
    s_add_u32 s24, s24, s63
    v_add_u32 v9, 27648, v7
    v_add_u32 v7, 9216, v7
    v_add_u32 v10, 3072, v12
    v_add_u32 v11, 2176, v12
    v_add_u32 v12, 1280, v12
    s_mov_b32 s22, 40960
    s_mov_b32 s26, 7560576
    s_lshl_b32 s50, s50, 7
    s_waitcnt lgkmcnt(0)
    s_add_u32 s20, s4, s20
    s_addc_u32 s21, s5, 0
    s_add_u32 s24, s10, s24
    s_addc_u32 s25, s11, 0
    s_sub_u32 s24, s24, 3072
    s_subb_u32 s25, s25, 0
    s_xor_b32 s51, s50, 0
    buffer_load_dwordx4 v6, s[20:23], s51 offen offset:0 lds
    buffer_load_dwordx4 v7, s[20:23], s51 offen offset:1024 lds
    buffer_load_dwordx4 v8, s[20:23], s51 offen offset:2048 lds
    buffer_load_dwordx4 v9, s[20:23], s51 offen offset:3072 lds
    s_add_u32 m0, s49, 4096
    s_mul_i32 s62, s51, 6144
    buffer_load_dwordx4 v10, s[24:27], s62 offen offset:0 nt lds
    buffer_load_dwordx4 v11, s[24:27], s62 offen offset:1024 nt lds
    buffer_load_dwordx4 v12, s[24:27], s62 offen offset:2048 nt lds
    s_add_u32 m0, s49, 7168
    s_add_u32 s62, s62, 393216
    buffer_load_dwordx4 v10, s[24:27], s62 offen offset:0 nt lds
    buffer_load_dwordx4 v11, s[24:27], s62 offen offset:1024 nt lds
    buffer_load_dwordx4 v12, s[24:27], s62 offen offset:2048 nt lds
.LA2:
    s_add_u32 s28, s6, s28
    s_addc_u32 s29, s7, 0
    s_mov_b32 s30, 12288
    s_mov_b32 s31, 0x20000
    s_mov_b32 s40, s18
    s_mov_b32 s41, s19
    s_mov_b32 s42, 7409664
    s_mov_b32 s43, 0x20000
    s_lshl_b32 s69, s66, 7
    v_lshrrev_b32 v38, 5, v1
    v_and_b32 v33, 31, v1
    v_bfe_u32 v34, v1, 1, 3
    v_xor_b32 v34, v34, v38
    v_lshlrev_b32 v34, 4, v34
    v_lshl_add_u32 v13, v33, 7, v34
    v_add_u32 v13, s49, v13
    v_and_b32 v33, 16, v1
    v_lshlrev_b32 v33, 1, v33
    v_and_b32 v34, 1, v1
    v_lshl_add_u32 v33, v34, 4, v33
    v_and_b32 v34, 2, v1
    v_lshl_add_u32 v33, v34, 2, v33
    v_bfe_u32 v34, v1, 2, 2
    v_lshl_add_u32 v21, v34, 7, v33
    v_and_b32 v35, 8, v1
    v_lshl_add_u32 v21, v35, 3, v21
    v_mul_u32_u24 v35, 40960, v38
    v_add_u32 v21, v21, v35
    v_xor_b32 v22, 64, v21
    v_add_u32 v23, 81920, v21
    v_add_u32 v24, 81920, v22
    v_lshlrev_b32 v0, 4, v1
    v_and_b32 v31, 7, v1
    v_lshlrev_b32 v31, 1, v31
    s_mov_b32 s54, 0x00010001
    v_xor_b32 v14, 32, v13
    v_xor_b32 v15, 64, v13
    v_xor_b32 v16, 96, v13
    s_mul_i32 s32, s2, 57344
    s_lshl_b32 s61, s48, 11
    s_add_u32 s61, s61, 4096
    s_mul_i32 s33, s48, 10240
    s_add_u32 s33, s33, s32
    s_add_u32 s32, s32, s61
    s_add_u32 m0, s49, 10240
    s_xor_b32 s51, s50, 128
    buffer_load_dwordx4 v6, s[20:23], s51 offen offset:0 lds
    buffer_load_dwordx4 v7, s[20:23], s51 offen offset:1024 lds
    buffer_load_dwordx4 v8, s[20:23], s51 offen offset:2048 lds
    buffer_load_dwordx4 v9, s[20:23], s51 offen offset:3072 lds
    s_add_u32 m0, s49, 14336
    s_mul_i32 s62, s51, 6144
    buffer_load_dwordx4 v10, s[24:27], s62 offen offset:0 lds
    buffer_load_dwordx4 v11, s[24:27], s62 offen offset:1024 lds
    buffer_load_dword v30, off, s[40:43], s69
    s_cmp_eq_u32 s48, 1
    s_cbranch_scc1 .LstA1
    s_cmp_eq_u32 s48, 2
    s_cbranch_scc1 .LstA2
    s_branch .LmA
.LB:
    s_mul_i32 s20, s62, 12288
    s_mul_i32 s24, s61, 245760
    s_lshr_b32 s63, s65, 1
    s_mul_i32 s63, s63, 640
    s_add_u32 s24, s24, s63
    s_mul_i32 s68, s48, 10240
    s_add_u32 s24, s24, s68
    s_and_b32 s51, s50, 1
    s_lshr_b32 s50, s50, 1
    s_and_b32 s63, s65, 1
    v_mul_u32_u24 v9, 1280, v33
    v_add_u32 v9, v9, v35
    s_mul_i32 s61, s63, 384
    s_mul_i32 s62, s51, 40960
    s_add_u32 s60, s61, s62
    s_sub_u32 s61, s61, s62
    s_add_u32 s60, s60, 3072
    s_add_u32 s61, s61, 41984
    v_add_u32 v6, s60, v9
    s_mov_b32 s53, s60
    v_add_u32 v8, s61, v9
    v_subrev_u32 v7, 896, v6
    v_subrev_u32 v9, 896, v8
    s_lshl_b32 s55, s51, 8
    s_mov_b32 s56, 128
    s_sub_u32 s57, 256, s55
    s_mul_i32 s58, s55, 640
    s_mov_b32 s59, 81920
    s_mul_i32 s60, s57, 640
    s_mul_i32 s32, s50, 12288
    s_mul_i32 s36, s50, 245760
    s_mov_b32 s22, 49152
    s_mov_b32 s26, 986112
    s_lshl_b32 s3, s63, 6
    s_add_u32 s68, s68, s3
    s_waitcnt lgkmcnt(0)
    s_add_u32 s20, s8, s20
    s_addc_u32 s21, s9, 0
    s_add_u32 s24, s12, s24
    s_addc_u32 s25, s13, 0
    s_sub_u32 s24, s24, 3072
    s_subb_u32 s25, s25, 0
    s_add_u32 s62, s32, s55
    buffer_load_dwordx4 v2, s[20:23], s62 offen offset:0 nt lds
    buffer_load_dwordx4 v3, s[20:23], s62 offen offset:1024 nt lds
    buffer_load_dwordx4 v4, s[20:23], s62 offen offset:2048 nt lds
    buffer_load_dwordx4 v5, s[20:23], s62 offen offset:3072 nt lds
    s_add_u32 m0, s49, 4096
    s_add_u32 s62, s36, s58
    buffer_load_dwordx4 v6, s[24:27], s62 offen offset:0 nt lds
    buffer_load_dwordx4 v7, s[24:27], s62 offen offset:1024 nt lds
    buffer_load_dwordx4 v8, s[24:27], s62 offen offset:2048 nt lds
    buffer_load_dwordx4 v9, s[24:27], s62 offen offset:3072 nt lds
    s_xor_b32 s3, s50, 1
    s_mul_i32 s33, s3, 12288
    s_mul_i32 s37, s3, 245760
    s_xor_b32 s3, s50, 2
    s_mul_i32 s34, s3, 12288
    s_mul_i32 s38, s3, 245760
    s_xor_b32 s3, s50, 3
    s_mul_i32 s35, s3, 12288
    s_mul_i32 s39, s3, 245760
    v_lshrrev_b32 v37, 2, v1
    v_mul_u32_u24 v11, 1280, v37
    v_and_b32 v37, 3, v1
    v_lshl_add_u32 v11, v37, 4, v11
    v_add_u32 v11, s68, v11
    s_add_u32 s4, s58, 3328
    s_add_u32 s5, s60, 1280
    s_add_u32 s3, s59, 2304
    v_add_u32 v10, s4, v11
    v_add_u32 v12, s5, v11
    v_add_u32 v11, s3, v11
    s_mov_b32 s40, s18
    s_mov_b32 s41, s19
    s_mov_b32 s42, 7409664
    s_mov_b32 s43, 0x20000
    s_lshl_b32 s69, s66, 7
    v_lshrrev_b32 v38, 5, v1
    v_and_b32 v33, 31, v1
    v_bfe_u32 v34, v1, 1, 3
    v_xor_b32 v34, v34, v38
    v_lshlrev_b32 v34, 4, v34
    v_lshl_add_u32 v13, v33, 7, v34
    v_add_u32 v13, s49, v13
    v_and_b32 v33, 16, v1
    v_lshlrev_b32 v33, 1, v33
    v_and_b32 v34, 1, v1
    v_lshl_add_u32 v33, v34, 4, v33
    v_and_b32 v34, 2, v1
    v_lshl_add_u32 v33, v34, 2, v33
    v_bfe_u32 v34, v1, 2, 2
    v_lshl_add_u32 v21, v34, 7, v33
    v_and_b32 v35, 8, v1
    v_lshl_add_u32 v21, v35, 3, v21
    v_mul_u32_u24 v35, 40960, v38
    v_add_u32 v21, v21, v35
    v_xor_b32 v22, 64, v21
    v_add_u32 v23, 81920, v21
    v_add_u32 v24, 81920, v22
    v_lshlrev_b32 v0, 4, v1
    v_and_b32 v31, 7, v1
    v_lshlrev_b32 v31, 1, v31
    s_mov_b32 s54, 0x00010001
    s_lshl_b32 s4, s51, 6
    v_xor_b32 v17, s4, v13
    v_xor_b32 v18, 32, v17
    v_xor_b32 v19, 64, v17
    v_xor_b32 v20, 96, v17
    v_lshl_add_u32 v34, v38, 3, v34
    v_lshl_add_u32 v33, v34, 6, v33
    s_mul_i32 s4, s51, 81920
    s_sub_u32 s5, 81920, s4
    v_add_u32 v25, s4, v33
    v_add_u32 v27, s5, v33
    v_add_u32 v26, 40960, v25
    v_add_u32 v28, 40960, v27
    s_add_u32 m0, s49, 8192
    s_add_u32 s62, s32, s56
    buffer_load_dwordx4 v2, s[20:23], s62 offen offset:0 lds
    buffer_load_dwordx4 v3, s[20:23], s62 offen offset:1024 lds
    buffer_load_dwordx4 v4, s[20:23], s62 offen offset:2048 lds
    buffer_load_dwordx4 v5, s[20:23], s62 offen offset:3072 lds
    s_add_u32 m0, s49, 12288
    s_add_u32 s62, s36, s59
    buffer_load_dwordx4 v6, s[24:27], s62 offen offset:0 lds
    buffer_load_dwordx4 v7, s[24:27], s62 offen offset:1024 lds
    buffer_load_dwordx4 v8, s[24:27], s62 offen offset:2048 lds
    buffer_load_dwordx4 v9, s[24:27], s62 offen offset:3072 lds
    buffer_load_dword v30, off, s[40:43], s69
    s_cmp_eq_u32 s48, 1
    s_cbranch_scc1 .LstB1
    s_cmp_eq_u32 s48, 2
    s_cbranch_scc1 .LstB2
    s_branch .LmB
.Lend:
    s_endpgm

.p2align 12
.LmA:
    s_waitcnt vmcnt(10)
    s_barrier
    ds_read_b64_tr_b16 a[0:1], v21 offset:4096
    ds_read_b64_tr_b16 a[2:3], v21 offset:4608
    ds_read_b128 a[48:51], v13 offset:0
    ds_read_b128 a[52:55], v14 offset:0
    ds_read_b128 a[56:59], v15 offset:0
    ds_read_b128 a[60:63], v16 offset:0
    ds_read_b64_tr_b16 a[4:5], v22 offset:4096
    ds_read_b64_tr_b16 a[6:7], v22 offset:4608
    ds_read_b64_tr_b16 a[8:9], v23 offset:4096
    ds_read_b64_tr_b16 a[10:11], v23 offset:4608
    ds_read_b64_tr_b16 a[12:13], v24 offset:4096
    ds_read_b64_tr_b16 a[14:15], v24 offset:4608
    ds_read_b64_tr_b16 a[16:17], v21 offset:5120
    ds_read_b64_tr_b16 a[18:19], v21 offset:5632
    ds_read_b64_tr_b16 a[20:21], v22 offset:5120
    ds_read_b64_tr_b16 a[22:23], v22 offset:5632
    s_waitcnt lgkmcnt(8)
    v_mfma_f32_32x32x16_bf16 v[40:55], a[0:3], a[48:51], 0
    ds_read_b64_tr_b16 a[24:25], v23 offset:5120
    ds_read_b64_tr_b16 a[26:27], v23 offset:5632
    buffer_load_dwordx4 v12, s[24:27], s62 offen offset:2048 lds
    v_mfma_f32_32x32x16_bf16 v[56:71], a[4:7], a[48:51], 0
    ds_read_b64_tr_b16 a[28:29], v24 offset:5120
    ds_read_b64_tr_b16 a[30:31], v24 offset:5632
    s_add_u32 m0, s49, 17408
    s_add_u32 s62, s62, 393216
    buffer_load_dwordx4 v10, s[24:27], s62 offen offset:0 lds
    s_waitcnt lgkmcnt(8)
    v_mfma_f32_32x32x16_bf16 v[40:55], a[8:11], a[52:55], v[40:55]
    ds_read_b64_tr_b16 a[32:33], v21 offset:6144
    ds_read_b64_tr_b16 a[34:35], v21 offset:6656
    buffer_load_dwordx4 v11, s[24:27], s62 offen offset:1024 lds
    v_mfma_f32_32x32x16_bf16 v[56:71], a[12:15], a[52:55], v[56:71]
    ds_read_b64_tr_b16 a[36:37], v22 offset:6144
    ds_read_b64_tr_b16 a[38:39], v22 offset:6656
    buffer_load_dwordx4 v12, s[24:27], s62 offen offset:2048 lds
    s_waitcnt lgkmcnt(8)
    v_mfma_f32_32x32x16_bf16 v[72:87], a[16:19], a[48:51], 0
    ds_read_b64_tr_b16 a[0:1], v23 offset:6144
    ds_read_b64_tr_b16 a[2:3], v23 offset:6656
    s_add_u32 m0, s49, 20480
    s_xor_b32 s51, s50, 256
    buffer_load_dwordx4 v6, s[20:23], s51 offen offset:0 lds
    v_mfma_f32_32x32x16_bf16 v[88:103], a[20:23], a[48:51], 0
    ds_read_b64_tr_b16 a[4:5], v24 offset:6144
    ds_read_b64_tr_b16 a[6:7], v24 offset:6656
    buffer_load_dwordx4 v7, s[20:23], s51 offen offset:1024 lds
    s_waitcnt lgkmcnt(8)
    v_mfma_f32_32x32x16_bf16 v[72:87], a[24:27], a[52:55], v[72:87]
    s_waitcnt vmcnt(13)
    s_barrier
    ds_read_b64_tr_b16 a[8:9], v21 offset:7168
    ds_read_b64_tr_b16 a[10:11], v21 offset:7680
    v_mfma_f32_32x32x16_bf16 v[88:103], a[28:31], a[52:55], v[88:103]
    ds_read_b64_tr_b16 a[12:13], v22 offset:7168
    ds_read_b64_tr_b16 a[14:15], v22 offset:7680
    buffer_load_dwordx4 v8, s[20:23], s51 offen offset:2048 lds
    s_waitcnt lgkmcnt(8)
    v_mfma_f32_32x32x16_bf16 v[104:119], a[32:35], a[48:51], 0
    ds_read_b64_tr_b16 a[16:17], v23 offset:7168
    ds_read_b64_tr_b16 a[18:19], v23 offset:7680
    buffer_load_dwordx4 v9, s[20:23], s51 offen offset:3072 lds
    v_mfma_f32_32x32x16_bf16 v[120:135], a[36:39], a[48:51], 0
    ds_read_b64_tr_b16 a[20:21], v24 offset:7168
    ds_read_b64_tr_b16 a[22:23], v24 offset:7680
    s_waitcnt lgkmcnt(8)
    v_mfma_f32_32x32x16_bf16 v[104:119], a[0:3], a[52:55], v[104:119]
    ds_read_b64_tr_b16 a[24:25], v21 offset:8192
    ds_read_b64_tr_b16 a[26:27], v21 offset:8704
    s_add_u32 m0, s49, 24576
    s_mul_i32 s62, s51, 6144
    buffer_load_dwordx4 v10, s[24:27], s62 offen offset:0 lds
    v_mfma_f32_32x32x16_bf16 v[120:135], a[4:7], a[52:55], v[120:135]
    ds_read_b64_tr_b16 a[28:29], v22 offset:8192
    ds_read_b64_tr_b16 a[30:31], v22 offset:8704
    buffer_load_dwordx4 v11, s[24:27], s62 offen offset:1024 lds
    s_waitcnt lgkmcnt(8)
    v_mfma_f32_32x32x16_bf16 v[40:55], a[8:11], a[56:59], v[40:55]
    ds_read_b64_tr_b16 a[32:33], v23 offset:8192
    ds_read_b64_tr_b16 a[34:35], v23 offset:8704
    v_mfma_f32_32x32x16_bf16 v[56:71], a[12:15], a[56:59], v[56:71]
    ds_read_b64_tr_b16 a[36:37], v24 offset:8192
    ds_read_b64_tr_b16 a[38:39], v24 offset:8704
    buffer_load_dwordx4 v12, s[24:27], s62 offen offset:2048 lds
    s_waitcnt lgkmcnt(8)
    v_mfma_f32_32x32x16_bf16 v[40:55], a[16:19], a[60:63], v[40:55]
    ds_read_b64_tr_b16 a[0:1], v21 offset:9216
    ds_read_b64_tr_b16 a[2:3], v21 offset:9728
    s_add_u32 m0, s49, 27648
    s_add_u32 s62, s62, 393216
    buffer_load_dwordx4 v10, s[24:27], s62 offen offset:0 lds
    v_mfma_f32_32x32x16_bf16 v[56:71], a[20:23], a[60:63], v[56:71]
    ds_read_b64_tr_b16 a[4:5], v22 offset:9216
    ds_read_b64_tr_b16 a[6:7], v22 offset:9728
    s_waitcnt lgkmcnt(8)
    v_mfma_f32_32x32x16_bf16 v[72:87], a[24:27], a[56:59], v[72:87]
    ds_read_b64_tr_b16 a[8:9], v23 offset:9216
    ds_read_b64_tr_b16 a[10:11], v23 offset:9728
    buffer_load_dwordx4 v11, s[24:27], s62 offen offset:1024 lds
    v_mfma_f32_32x32x16_bf16 v[88:103], a[28:31], a[56:59], v[88:103]
    ds_read_b64_tr_b16 a[12:13], v24 offset:9216
    ds_read_b64_tr_b16 a[14:15], v24 offset:9728
    s_waitcnt vmcnt(16)
    ds_read_b128 a[64:67], v13 offset:10240
    buffer_load_dwordx4 v12, s[24:27], s62 offen offset:2048 lds
    s_waitcnt lgkmcnt(9)
    v_mfma_f32_32x32x16_bf16 v[72:87], a[32:35], a[60:63], v[72:87]
    s_waitcnt vmcnt(13)
    s_barrier
    ds_read_b64_tr_b16 a[16:17], v21 offset:14336
    ds_read_b64_tr_b16 a[18:19], v21 offset:14848
    ds_read_b128 a[68:71], v14 offset:10240
    ds_read_b128 a[72:75], v15 offset:10240
    v_mfma_f32_32x32x16_bf16 v[88:103], a[36:39], a[60:63], v[88:103]
    ds_read_b64_tr_b16 a[20:21], v22 offset:14336
    ds_read_b64_tr_b16 a[22:23], v22 offset:14848
    s_add_u32 m0, s49, 30720
    s_xor_b32 s51, s50, 384
    buffer_load_dwordx4 v6, s[20:23], s51 offen offset:0 nt lds
    s_waitcnt lgkmcnt(11)
    v_mfma_f32_32x32x16_bf16 v[104:119], a[0:3], a[56:59], v[104:119]
    ds_read_b64_tr_b16 a[24:25], v23 offset:14336
    ds_read_b64_tr_b16 a[26:27], v23 offset:14848
    ds_read_b128 a[76:79], v16 offset:10240
    buffer_load_dwordx4 v7, s[20:23], s51 offen offset:1024 nt lds
    v_readfirstlane_b32 s69, v30
    v_mfma_f32_32x32x16_bf16 v[120:135], a[4:7], a[56:59], v[120:135]
    ds_read_b64_tr_b16 a[28:29], v24 offset:14336
    ds_read_b64_tr_b16 a[30:31], v24 offset:14848
    buffer_load_dwordx4 v8, s[20:23], s51 offen offset:2048 nt lds
    s_add_u32 s69, s69, 2654435761
    v_lshrrev_b32 v30, v31, s69
    s_waitcnt lgkmcnt(12)
    v_mfma_f32_32x32x16_bf16 v[104:119], a[8:11], a[60:63], v[104:119]
    ds_read_b64_tr_b16 a[32:33], v21 offset:15360
    ds_read_b64_tr_b16 a[34:35], v21 offset:15872
    v_lshrrev_b32 v31, 1, v30
    s_mov_b32 s44, s14
    s_mov_b32 s45, s15
    s_mov_b32 s46, 655360
    v_mfma_f32_32x32x16_bf16 v[120:135], a[12:15], a[60:63], v[120:135]
    ds_read_b64_tr_b16 a[36:37], v22 offset:15360
    ds_read_b64_tr_b16 a[38:39], v22 offset:15872
    buffer_load_dwordx4 v9, s[20:23], s51 offen offset:3072 nt lds
    s_mov_b32 s47, 0x20000
    s_mov_b32 s52, 0x3dd53b95
    s_waitcnt lgkmcnt(9)
    v_mfma_f32_32x32x16_bf16 v[40:55], a[16:19], a[64:67], v[40:55]
    ds_read_b64_tr_b16 a[0:1], v23 offset:15360
    ds_read_b64_tr_b16 a[2:3], v23 offset:15872
    s_add_u32 m0, s49, 34816
    s_mul_i32 s62, s51, 6144
    buffer_load_dwordx4 v10, s[24:27], s62 offen offset:0 nt lds
    v_mfma_f32_32x32x16_bf16 v[56:71], a[20:23], a[64:67], v[56:71]
    ds_read_b64_tr_b16 a[4:5], v24 offset:15360
    ds_read_b64_tr_b16 a[6:7], v24 offset:15872
    s_add_u32 s33, s33, 20480
    s_add_u32 s34, s33, 4096
    s_add_u32 s35, s33, 8192
    s_lshl_b32 s4, s66, 3
    s_waitcnt lgkmcnt(8)
    v_mfma_f32_32x32x16_bf16 v[40:55], a[24:27], a[68:71], v[40:55]
    ds_read_b64_tr_b16 a[8:9], v21 offset:16384
    ds_read_b64_tr_b16 a[10:11], v21 offset:16896
    buffer_load_dwordx4 v11, s[24:27], s62 offen offset:1024 nt lds
    s_add_u32 s4, s4, s64
    s_mul_i32 s4, s4, 20480
    v_mfma_f32_32x32x16_bf16 v[56:71], a[28:31], a[68:71], v[56:71]
    ds_read_b64_tr_b16 a[12:13], v22 offset:16384
    ds_read_b64_tr_b16 a[14:15], v22 offset:16896
    buffer_load_dwordx4 v12, s[24:27], s62 offen offset:2048 nt lds
    s_lshr_b32 s5, s65, 1
    s_mul_i32 s5, s5, 640
    s_waitcnt lgkmcnt(8)
    v_mfma_f32_32x32x16_bf16 v[72:87], a[32:35], a[64:67], v[72:87]
    ds_read_b64_tr_b16 a[16:17], v23 offset:16384
    ds_read_b64_tr_b16 a[18:19], v23 offset:16896
    s_add_u32 s4, s4, s5
    s_lshl_b32 s5, s48, 4
    s_add_u32 s4, s4, s5
    s_and_b32 s5, s65, 1
    v_mfma_f32_32x32x16_bf16 v[88:103], a[36:39], a[64:67], v[88:103]
    ds_read_b64_tr_b16 a[20:21], v24 offset:16384
    ds_read_b64_tr_b16 a[22:23], v24 offset:16896
    s_add_u32 m0, s49, 37888
    s_add_u32 s62, s62, 393216
    buffer_load_dwordx4 v10, s[24:27], s62 offen offset:0 nt lds
    s_waitcnt lgkmcnt(8)
    v_mfma_f32_32x32x16_bf16 v[72:87], a[0:3], a[68:71], v[72:87]
    s_waitcnt vmcnt(18)
    s_barrier
    ds_read_b64_tr_b16 a[24:25], v21 offset:17408
    ds_read_b64_tr_b16 a[26:27], v21 offset:17920
    buffer_load_dwordx4 v11, s[24:27], s62 offen offset:1024 nt lds
    v_mfma_f32_32x32x16_bf16 v[88:103], a[4:7], a[68:71], v[88:103]
    ds_read_b64_tr_b16 a[28:29], v22 offset:17408
    ds_read_b64_tr_b16 a[30:31], v22 offset:17920
    s_mul_i32 s6, s5, 384
    s_add_u32 s36, s4, s6
    s_add_u32 s37, s36, 10240
    s_lshl_b32 s5, s5, 6
    s_waitcnt lgkmcnt(8)
    v_mfma_f32_32x32x16_bf16 v[104:119], a[8:11], a[64:67], v[104:119]
    ds_read_b64_tr_b16 a[32:33], v23 offset:17408
    ds_read_b64_tr_b16 a[34:35], v23 offset:17920
    buffer_load_dwordx4 v12, s[24:27], s62 offen offset:2048 nt lds
    s_add_u32 s4, s4, s5
    s_add_u32 s38, s4, 256
    v_mfma_f32_32x32x16_bf16 v[120:135], a[12:15], a[64:67], v[120:135]
    ds_read_b64_tr_b16 a[36:37], v24 offset:17408
    ds_read_b64_tr_b16 a[38:39], v24 offset:17920
    s_add_u32 m0, s49, 0
    s_xor_b32 s51, s50, 512
    buffer_load_dwordx4 v6, s[20:23], s51 offen offset:0 lds
    s_waitcnt lgkmcnt(8)
    v_mfma_f32_32x32x16_bf16 v[104:119], a[16:19], a[68:71], v[104:119]
    ds_read_b64_tr_b16 a[0:1], v21 offset:18432
    ds_read_b64_tr_b16 a[2:3], v21 offset:18944
    buffer_load_dwordx4 v7, s[20:23], s51 offen offset:1024 lds
    v_and_b32 v33, 7, v1
    v_mul_u32_u24 v32, 1280, v33
    v_mfma_f32_32x32x16_bf16 v[120:135], a[20:23], a[68:71], v[120:135]
    ds_read_b64_tr_b16 a[4:5], v22 offset:18432
    ds_read_b64_tr_b16 a[6:7], v22 offset:18944
    v_lshlrev_b32 v17, 9, v33
    v_bfe_u32 v33, v1, 4, 1
    v_lshl_add_u32 v32, v33, 3, v32
    v_and_b32 v33, 8, v1
    s_waitcnt lgkmcnt(8)
    v_mfma_f32_32x32x16_bf16 v[40:55], a[24:27], a[72:75], v[40:55]
    ds_read_b64_tr_b16 a[8:9], v23 offset:18432
    ds_read_b64_tr_b16 a[10:11], v23 offset:18944
    buffer_load_dwordx4 v8, s[20:23], s51 offen offset:2048 lds
    v_mul_u32_u24 v19, 1280, v33
    v_add_u32 v19, v19, v32
    v_mfma_f32_32x32x16_bf16 v[56:71], a[28:31], a[72:75], v[56:71]
    ds_read_b64_tr_b16 a[12:13], v24 offset:18432
    ds_read_b64_tr_b16 a[14:15], v24 offset:18944
    buffer_load_dwordx4 v9, s[20:23], s51 offen offset:3072 lds
    v_lshl_add_u32 v32, v33, 3, v32
    v_lshl_add_u32 v32, v38, 7, v32
    s_waitcnt lgkmcnt(8)
    v_mfma_f32_32x32x16_bf16 v[40:55], a[32:35], a[76:79], v[40:55]
    ds_read_b64_tr_b16 a[16:17], v21 offset:19456
    ds_read_b64_tr_b16 a[18:19], v21 offset:19968
    v_lshrrev_b32 v18, 4, v1
    s_andn2_b32 s4, s2, 7
    s_lshl_b32 s4, s4, 2
    s_lshr_b32 s5, s64, 1
    v_mfma_f32_32x32x16_bf16 v[56:71], a[36:39], a[76:79], v[56:71]
    ds_read_b64_tr_b16 a[20:21], v22 offset:19456
    ds_read_b64_tr_b16 a[22:23], v22 offset:19968
    s_add_u32 m0, s49, 4096
    s_mul_i32 s62, s51, 6144
    buffer_load_dwordx4 v10, s[24:27], s62 offen offset:0 lds
    s_waitcnt lgkmcnt(8)
    v_mfma_f32_32x32x16_bf16 v[72:87], a[0:3], a[72:75], v[72:87]
    ds_read_b64_tr_b16 a[24:25], v23 offset:19456
    ds_read_b64_tr_b16 a[26:27], v23 offset:19968
    buffer_load_dwordx4 v11, s[24:27], s62 offen offset:1024 lds
    s_add_u32 s4, s4, s5
    s_lshl_b32 s4, s4, 7
    v_mfma_f32_32x32x16_bf16 v[88:103], a[4:7], a[72:75], v[88:103]
    ds_read_b64_tr_b16 a[28:29], v24 offset:19456
    ds_read_b64_tr_b16 a[30:31], v24 offset:19968
    s_waitcnt vmcnt(22)
    ds_read_b128 a[48:51], v13 offset:20480
    ds_read_b128 a[52:55], v14 offset:20480
    s_add_u32 s4, s4, 7344128
    s_waitcnt lgkmcnt(10)
    v_mfma_f32_32x32x16_bf16 v[72:87], a[8:11], a[76:79], v[72:87]
    s_waitcnt vmcnt(19)
    s_barrier
    ds_read_b64_tr_b16 a[32:33], v21 offset:24576
    ds_read_b64_tr_b16 a[34:35], v21 offset:25088
    buffer_load_dwordx4 v12, s[24:27], s62 offen offset:2048 lds
    v_mfma_f32_32x32x16_bf16 v[88:103], a[12:15], a[76:79], v[88:103]
    ds_read_b64_tr_b16 a[36:37], v22 offset:24576
    ds_read_b64_tr_b16 a[38:39], v22 offset:25088
    ds_read_b128 a[56:59], v15 offset:20480
    s_add_u32 m0, s49, 7168
    s_add_u32 s62, s62, 393216
    buffer_load_dwordx4 v10, s[24:27], s62 offen offset:0 lds
    s_waitcnt lgkmcnt(11)
    v_mfma_f32_32x32x16_bf16 v[104:119], a[16:19], a[72:75], v[104:119]
    ds_read_b64_tr_b16 a[0:1], v23 offset:24576
    ds_read_b64_tr_b16 a[2:3], v23 offset:25088
    ds_read_b128 a[60:63], v16 offset:20480
    v_and_b32 v33, 1, v1
    v_lshlrev_b32 v33, 4, v33
    v_mov_b32 v34, 0x3f80
    v_mfma_f32_32x32x16_bf16 v[120:135], a[20:23], a[72:75], v[120:135]
    ds_read_b64_tr_b16 a[4:5], v24 offset:24576
    ds_read_b64_tr_b16 a[6:7], v24 offset:25088
    buffer_load_dwordx4 v11, s[24:27], s62 offen offset:1024 lds
    v_lshlrev_b32 v33, v33, v34
    v_bfe_u32 v35, v1, 1, 3
    s_waitcnt lgkmcnt(12)
    v_mfma_f32_32x32x16_bf16 v[104:119], a[24:27], a[76:79], v[104:119]
    ds_read_b64_tr_b16 a[8:9], v21 offset:25600
    ds_read_b64_tr_b16 a[10:11], v21 offset:26112
    buffer_load_dwordx4 v12, s[24:27], s62 offen offset:2048 lds
    v_cmp_eq_u32 vcc, 0, v35
    v_mfma_f32_32x32x16_bf16 v[120:135], a[28:31], a[76:79], v[120:135]
    ds_read_b64_tr_b16 a[12:13], v22 offset:25600
    ds_read_b64_tr_b16 a[14:15], v22 offset:26112
    s_add_u32 m0, s49, 10240
    s_xor_b32 s51, s50, 640
    buffer_load_dwordx4 v6, s[20:23], s51 offen offset:0 lds
    s_waitcnt lgkmcnt(10)
    v_mfma_f32_32x32x16_bf16 v[40:55], a[32:35], a[48:51], v[40:55]
    ds_read_b64_tr_b16 a[16:17], v23 offset:25600
    ds_read_b64_tr_b16 a[18:19], v23 offset:26112
    v_cndmask_b32 v34, 0, v33, vcc
    v_accvgpr_write_b32 a128, v34
    v_cmp_eq_u32 vcc, 1, v35
    v_mfma_f32_32x32x16_bf16 v[56:71], a[36:39], a[48:51], v[56:71]
    ds_read_b64_tr_b16 a[20:21], v24 offset:25600
    ds_read_b64_tr_b16 a[22:23], v24 offset:26112
    buffer_load_dwordx4 v7, s[20:23], s51 offen offset:1024 lds
    v_cndmask_b32 v34, 0, v33, vcc
    v_accvgpr_write_b32 a129, v34
    s_waitcnt lgkmcnt(8)
    v_mfma_f32_32x32x16_bf16 v[40:55], a[0:3], a[52:55], v[40:55]
    ds_read_b64_tr_b16 a[24:25], v21 offset:26624
    ds_read_b64_tr_b16 a[26:27], v21 offset:27136
    buffer_load_dwordx4 v8, s[20:23], s51 offen offset:2048 lds
    v_cmp_eq_u32 vcc, 2, v35
    v_mfma_f32_32x32x16_bf16 v[56:71], a[4:7], a[52:55], v[56:71]
    ds_read_b64_tr_b16 a[28:29], v22 offset:26624
    ds_read_b64_tr_b16 a[30:31], v22 offset:27136
    v_cndmask_b32 v34, 0, v33, vcc
    v_accvgpr_write_b32 a130, v34
    v_cmp_eq_u32 vcc, 3, v35
    s_waitcnt lgkmcnt(8)
    v_mfma_f32_32x32x16_bf16 v[72:87], a[8:11], a[48:51], v[72:87]
    ds_read_b64_tr_b16 a[32:33], v23 offset:26624
    ds_read_b64_tr_b16 a[34:35], v23 offset:27136
    buffer_load_dwordx4 v9, s[20:23], s51 offen offset:3072 lds
    v_cndmask_b32 v34, 0, v33, vcc
    v_accvgpr_write_b32 a131, v34
    v_mfma_f32_32x32x16_bf16 v[88:103], a[12:15], a[48:51], v[88:103]
    ds_read_b64_tr_b16 a[36:37], v24 offset:26624
    ds_read_b64_tr_b16 a[38:39], v24 offset:27136
    s_add_u32 m0, s49, 14336
    s_mul_i32 s62, s51, 6144
    buffer_load_dwordx4 v10, s[24:27], s62 offen offset:0 lds
    s_waitcnt lgkmcnt(8)
    v_mfma_f32_32x32x16_bf16 v[72:87], a[16:19], a[52:55], v[72:87]
    s_waitcnt vmcnt(25)
    s_barrier
    ds_read_b64_tr_b16 a[0:1], v21 offset:27648
    ds_read_b64_tr_b16 a[2:3], v21 offset:28160
    v_cmp_eq_u32 vcc, 4, v35
    v_mfma_f32_32x32x16_bf16 v[88:103], a[20:23], a[52:55], v[88:103]
    ds_read_b64_tr_b16 a[4:5], v22 offset:27648
    ds_read_b64_tr_b16 a[6:7], v22 offset:28160
    buffer_load_dwordx4 v11, s[24:27], s62 offen offset:1024 lds
    v_cndmask_b32 v34, 0, v33, vcc
    v_accvgpr_write_b32 a132, v34
    s_waitcnt lgkmcnt(8)
    v_mfma_f32_32x32x16_bf16 v[104:119], a[24:27], a[48:51], v[104:119]
    ds_read_b64_tr_b16 a[8:9], v23 offset:27648
    ds_read_b64_tr_b16 a[10:11], v23 offset:28160
    buffer_load_dwordx4 v12, s[24:27], s62 offen offset:2048 lds
    v_cmp_eq_u32 vcc, 5, v35
    v_mfma_f32_32x32x16_bf16 v[120:135], a[28:31], a[48:51], v[120:135]
    ds_read_b64_tr_b16 a[12:13], v24 offset:27648
    ds_read_b64_tr_b16 a[14:15], v24 offset:28160
    v_cndmask_b32 v34, 0, v33, vcc
    v_accvgpr_write_b32 a133, v34
    v_cmp_eq_u32 vcc, 6, v35
    s_waitcnt lgkmcnt(8)
    v_mfma_f32_32x32x16_bf16 v[104:119], a[32:35], a[52:55], v[104:119]
    ds_read_b64_tr_b16 a[16:17], v21 offset:28672
    ds_read_b64_tr_b16 a[18:19], v21 offset:29184
    s_add_u32 m0, s49, 17408
    s_add_u32 s62, s62, 393216
    buffer_load_dwordx4 v10, s[24:27], s62 offen offset:0 lds
    v_mfma_f32_32x32x16_bf16 v[120:135], a[36:39], a[52:55], v[120:135]
    ds_read_b64_tr_b16 a[20:21], v22 offset:28672
    ds_read_b64_tr_b16 a[22:23], v22 offset:29184
    buffer_load_dwordx4 v11, s[24:27], s62 offen offset:1024 lds
    v_cndmask_b32 v34, 0, v33, vcc
    v_accvgpr_write_b32 a134, v34
    s_waitcnt lgkmcnt(8)
    v_mfma_f32_32x32x16_bf16 v[40:55], a[0:3], a[56:59], v[40:55]
    ds_read_b64_tr_b16 a[24:25], v23 offset:28672
    ds_read_b64_tr_b16 a[26:27], v23 offset:29184
    buffer_load_dwordx4 v12, s[24:27], s62 offen offset:2048 lds
    v_cmp_eq_u32 vcc, 7, v35
    v_mfma_f32_32x32x16_bf16 v[56:71], a[4:7], a[56:59], v[56:71]
    ds_read_b64_tr_b16 a[28:29], v24 offset:28672
    ds_read_b64_tr_b16 a[30:31], v24 offset:29184
    v_cndmask_b32 v34, 0, v33, vcc
    v_accvgpr_write_b32 a135, v34
    s_waitcnt lgkmcnt(8)
    v_mfma_f32_32x32x16_bf16 v[40:55], a[8:11], a[60:63], v[40:55]
    ds_read_b64_tr_b16 a[32:33], v21 offset:29696
    ds_read_b64_tr_b16 a[34:35], v21 offset:30208
    s_add_u32 m0, s49, 20480
    s_xor_b32 s51, s50, 768
    buffer_load_dwordx4 v6, s[20:23], s51 offen offset:0 lds
    v_mfma_f32_32x32x16_bf16 v[56:71], a[12:15], a[60:63], v[56:71]
    ds_read_b64_tr_b16 a[36:37], v22 offset:29696
    ds_read_b64_tr_b16 a[38:39], v22 offset:30208
    buffer_load_dwordx4 v7, s[20:23], s51 offen offset:1024 lds
    s_waitcnt lgkmcnt(8)
    v_mfma_f32_32x32x16_bf16 v[72:87], a[16:19], a[56:59], v[72:87]
    ds_read_b64_tr_b16 a[0:1], v23 offset:29696
    ds_read_b64_tr_b16 a[2:3], v23 offset:30208
    v_mfma_f32_32x32x16_bf16 v[88:103], a[20:23], a[56:59], v[88:103]
    ds_read_b64_tr_b16 a[4:5], v24 offset:29696
    ds_read_b64_tr_b16 a[6:7], v24 offset:30208
    s_waitcnt vmcnt(28)
    ds_read_b128 a[64:67], v13 offset:30720
    buffer_load_dwordx4 v8, s[20:23], s51 offen offset:2048 lds
    s_waitcnt lgkmcnt(9)
    v_mfma_f32_32x32x16_bf16 v[72:87], a[24:27], a[60:63], v[72:87]
    s_waitcnt vmcnt(26)
    s_barrier
    ds_read_b64_tr_b16 a[8:9], v21 offset:34816
    ds_read_b64_tr_b16 a[10:11], v21 offset:35328
    ds_read_b128 a[68:71], v14 offset:30720
    buffer_load_dwordx4 v9, s[20:23], s51 offen offset:3072 lds
    v_mfma_f32_32x32x16_bf16 v[88:103], a[28:31], a[60:63], v[88:103]
    ds_read_b64_tr_b16 a[12:13], v22 offset:34816
    ds_read_b64_tr_b16 a[14:15], v22 offset:35328
    ds_read_b128 a[72:75], v15 offset:30720
    ds_read_b128 a[76:79], v16 offset:30720
    s_waitcnt lgkmcnt(12)
    v_mfma_f32_32x32x16_bf16 v[104:119], a[32:35], a[56:59], v[104:119]
    ds_read_b64_tr_b16 a[16:17], v23 offset:34816
    ds_read_b64_tr_b16 a[18:19], v23 offset:35328
    v_mfma_f32_32x32x16_bf16 v[120:135], a[36:39], a[56:59], v[120:135]
    ds_read_b64_tr_b16 a[20:21], v24 offset:34816
    ds_read_b64_tr_b16 a[22:23], v24 offset:35328
    s_add_u32 m0, s49, 24576
    s_mul_i32 s62, s51, 6144
    buffer_load_dwordx4 v10, s[24:27], s62 offen offset:0 lds
    s_waitcnt lgkmcnt(12)
    v_mfma_f32_32x32x16_bf16 v[104:119], a[0:3], a[60:63], v[104:119]
    ds_read_b64_tr_b16 a[24:25], v21 offset:35840
    ds_read_b64_tr_b16 a[26:27], v21 offset:36352
    v_mfma_f32_32x32x16_bf16 v[120:135], a[4:7], a[60:63], v[120:135]
    ds_read_b64_tr_b16 a[28:29], v22 offset:35840
    ds_read_b64_tr_b16 a[30:31], v22 offset:36352
    buffer_load_dwordx4 v11, s[24:27], s62 offen offset:1024 lds
    s_waitcnt lgkmcnt(10)
    v_mfma_f32_32x32x16_bf16 v[40:55], a[8:11], a[64:67], v[40:55]
    ds_read_b64_tr_b16 a[32:33], v23 offset:35840
    ds_read_b64_tr_b16 a[34:35], v23 offset:36352
    v_mfma_f32_32x32x16_bf16 v[56:71], a[12:15], a[64:67], v[56:71]
    ds_read_b64_tr_b16 a[36:37], v24 offset:35840
    ds_read_b64_tr_b16 a[38:39], v24 offset:36352
    s_waitcnt lgkmcnt(8)
    v_mfma_f32_32x32x16_bf16 v[40:55], a[16:19], a[68:71], v[40:55]
    ds_read_b64_tr_b16 a[0:1], v21 offset:36864
    ds_read_b64_tr_b16 a[2:3], v21 offset:37376
    buffer_load_dwordx4 v12, s[24:27], s62 offen offset:2048 lds
    v_mfma_f32_32x32x16_bf16 v[56:71], a[20:23], a[68:71], v[56:71]
    ds_read_b64_tr_b16 a[4:5], v22 offset:36864
    ds_read_b64_tr_b16 a[6:7], v22 offset:37376
    s_waitcnt lgkmcnt(8)
    v_mfma_f32_32x32x16_bf16 v[72:87], a[24:27], a[64:67], v[72:87]
    ds_read_b64_tr_b16 a[8:9], v23 offset:36864
    ds_read_b64_tr_b16 a[10:11], v23 offset:37376
    s_add_u32 m0, s49, 30720
    s_add_u32 s62, s62, 393216
    buffer_load_dwordx4 v10, s[24:27], s62 offen offset:0 lds
    v_mfma_f32_32x32x16_bf16 v[88:103], a[28:31], a[64:67], v[88:103]
    ds_read_b64_tr_b16 a[12:13], v24 offset:36864
    ds_read_b64_tr_b16 a[14:15], v24 offset:37376
    s_waitcnt lgkmcnt(8)
    v_mfma_f32_32x32x16_bf16 v[72:87], a[32:35], a[68:71], v[72:87]
    s_waitcnt vmcnt(28)
    s_barrier
    ds_read_b64_tr_b16 a[16:17], v21 offset:37888
    ds_read_b64_tr_b16 a[18:19], v21 offset:38400
    buffer_load_dwordx4 v11, s[24:27], s62 offen offset:1024 lds
    v_mfma_f32_32x32x16_bf16 v[88:103], a[36:39], a[68:71], v[88:103]
    ds_read_b64_tr_b16 a[20:21], v22 offset:37888
    ds_read_b64_tr_b16 a[22:23], v22 offset:38400
    s_waitcnt lgkmcnt(8)
    v_mfma_f32_32x32x16_bf16 v[104:119], a[0:3], a[64:67], v[104:119]
    ds_read_b64_tr_b16 a[24:25], v23 offset:37888
    ds_read_b64_tr_b16 a[26:27], v23 offset:38400
    v_mfma_f32_32x32x16_bf16 v[120:135], a[4:7], a[64:67], v[120:135]
    ds_read_b64_tr_b16 a[28:29], v24 offset:37888
    ds_read_b64_tr_b16 a[30:31], v24 offset:38400
    buffer_load_dwordx4 v12, s[24:27], s62 offen offset:2048 lds
    s_waitcnt lgkmcnt(8)
    v_mfma_f32_32x32x16_bf16 v[104:119], a[8:11], a[68:71], v[104:119]
    ds_read_b64_tr_b16 a[32:33], v21 offset:38912
    ds_read_b64_tr_b16 a[34:35], v21 offset:39424
    v_mfma_f32_32x32x16_bf16 v[120:135], a[12:15], a[68:71], v[120:135]
    ds_read_b64_tr_b16 a[36:37], v22 offset:38912
    ds_read_b64_tr_b16 a[38:39], v22 offset:39424
    s_waitcnt lgkmcnt(8)
    v_mfma_f32_32x32x16_bf16 v[40:55], a[16:19], a[72:75], v[40:55]
    ds_read_b64_tr_b16 a[0:1], v23 offset:38912
    ds_read_b64_tr_b16 a[2:3], v23 offset:39424
    v_mfma_f32_32x32x16_bf16 v[56:71], a[20:23], a[72:75], v[56:71]
    ds_read_b64_tr_b16 a[4:5], v24 offset:38912
    ds_read_b64_tr_b16 a[6:7], v24 offset:39424
    s_waitcnt lgkmcnt(8)
    v_mfma_f32_32x32x16_bf16 v[40:55], a[24:27], a[76:79], v[40:55]
    ds_read_b64_tr_b16 a[8:9], v21 offset:39936
    ds_read_b64_tr_b16 a[10:11], v21 offset:40448
    v_mfma_f32_32x32x16_bf16 v[56:71], a[28:31], a[76:79], v[56:71]
    ds_read_b64_tr_b16 a[12:13], v22 offset:39936
    ds_read_b64_tr_b16 a[14:15], v22 offset:40448
    s_waitcnt lgkmcnt(8)
    v_mfma_f32_32x32x16_bf16 v[72:87], a[32:35], a[72:75], v[72:87]
    ds_read_b64_tr_b16 a[16:17], v23 offset:39936
    ds_read_b64_tr_b16 a[18:19], v23 offset:40448
    v_mfma_f32_32x32x16_bf16 v[88:103], a[36:39], a[72:75], v[88:103]
    ds_read_b64_tr_b16 a[20:21], v24 offset:39936
    ds_read_b64_tr_b16 a[22:23], v24 offset:40448
    s_waitcnt vmcnt(26)
    ds_read_b128 a[48:51], v13 offset:0
    ds_read_b128 a[52:55], v14 offset:0
    s_waitcnt lgkmcnt(10)
    v_mfma_f32_32x32x16_bf16 v[72:87], a[0:3], a[76:79], v[72:87]
    s_waitcnt vmcnt(23)
    s_barrier
    ds_read_b64_tr_b16 a[24:25], v21 offset:4096
    ds_read_b64_tr_b16 a[26:27], v21 offset:4608
    ds_read_b128 a[56:59], v15 offset:0
    v_mfma_f32_32x32x16_bf16 v[88:103], a[4:7], a[76:79], v[88:103]
    ds_read_b64_tr_b16 a[28:29], v22 offset:4096
    ds_read_b64_tr_b16 a[30:31], v22 offset:4608
    s_add_u32 m0, s49, 33792
    s_xor_b32 s51, s50, 896
    buffer_load_dwordx4 v6, s[20:23], s51 offen offset:0 nt lds
    s_waitcnt lgkmcnt(11)
    v_mfma_f32_32x32x16_bf16 v[104:119], a[8:11], a[72:75], v[104:119]
    ds_read_b64_tr_b16 a[32:33], v23 offset:4096
    ds_read_b64_tr_b16 a[34:35], v23 offset:4608
    ds_read_b128 a[60:63], v16 offset:0
    v_mfma_f32_32x32x16_bf16 v[120:135], a[12:15], a[72:75], v[120:135]
    ds_read_b64_tr_b16 a[36:37], v24 offset:4096
    ds_read_b64_tr_b16 a[38:39], v24 offset:4608
    buffer_load_dwordx4 v7, s[20:23], s51 offen offset:1024 nt lds
    s_waitcnt lgkmcnt(12)
    v_mfma_f32_32x32x16_bf16 v[104:119], a[16:19], a[76:79], v[104:119]
    ds_read_b64_tr_b16 a[0:1], v21 offset:5120
    ds_read_b64_tr_b16 a[2:3], v21 offset:5632
    v_mfma_f32_32x32x16_bf16 v[120:135], a[20:23], a[76:79], v[120:135]
    ds_read_b64_tr_b16 a[4:5], v22 offset:5120
    ds_read_b64_tr_b16 a[6:7], v22 offset:5632
    buffer_load_dwordx4 v8, s[20:23], s51 offen offset:2048 nt lds
    s_waitcnt lgkmcnt(9)
    v_mfma_f32_32x32x16_bf16 v[40:55], a[24:27], a[48:51], v[40:55]
    ds_read_b64_tr_b16 a[8:9], v23 offset:5120
    ds_read_b64_tr_b16 a[10:11], v23 offset:5632
    v_mfma_f32_32x32x16_bf16 v[56:71], a[28:31], a[48:51], v[56:71]
    ds_read_b64_tr_b16 a[12:13], v24 offset:5120
    ds_read_b64_tr_b16 a[14:15], v24 offset:5632
    buffer_load_dwordx4 v9, s[20:23], s51 offen offset:3072 nt lds
    s_waitcnt lgkmcnt(8)
    v_mfma_f32_32x32x16_bf16 v[40:55], a[32:35], a[52:55], v[40:55]
    ds_read_b64_tr_b16 a[16:17], v21 offset:6144
    ds_read_b64_tr_b16 a[18:19], v21 offset:6656
    s_add_u32 m0, s49, 0
    s_mul_i32 s62, s51, 6144
    buffer_load_dwordx4 v10, s[24:27], s62 offen offset:0 nt lds
    v_mfma_f32_32x32x16_bf16 v[56:71], a[36:39], a[52:55], v[56:71]
    s_branch .LskA1
.p2align 12
.LstA1:
    s_branch .LmA
.LskA1:
    ds_read_b64_tr_b16 a[20:21], v22 offset:6144
    ds_read_b64_tr_b16 a[22:23], v22 offset:6656
    s_waitcnt lgkmcnt(8)
    v_mfma_f32_32x32x16_bf16 v[72:87], a[0:3], a[48:51], v[72:87]
    ds_read_b64_tr_b16 a[24:25], v23 offset:6144
    ds_read_b64_tr_b16 a[26:27], v23 offset:6656
    buffer_load_dwordx4 v11, s[24:27], s62 offen offset:1024 nt lds
    buffer_load_dwordx4 v[160:163], v0, s[40:43], s32 offen offset:0 sc1
    v_mfma_f32_32x32x16_bf16 v[88:103], a[4:7], a[48:51], v[88:103]
    ds_read_b64_tr_b16 a[28:29], v24 offset:6144
    ds_read_b64_tr_b16 a[30:31], v24 offset:6656
    buffer_load_dwordx4 v[164:167], v0, s[40:43], s32 offen offset:1024 sc1
    s_waitcnt lgkmcnt(8)
    v_mfma_f32_32x32x16_bf16 v[72:87], a[8:11], a[52:55], v[72:87]
    s_waitcnt vmcnt(28)
    s_barrier
    ds_read_b64_tr_b16 a[32:33], v21 offset:7168
    ds_read_b64_tr_b16 a[34:35], v21 offset:7680
    buffer_load_dwordx4 v12, s[24:27], s62 offen offset:2048 nt lds
    v_mfma_f32_32x32x16_bf16 v[88:103], a[12:15], a[52:55], v[88:103]
    ds_read_b64_tr_b16 a[36:37], v22 offset:7168
    ds_read_b64_tr_b16 a[38:39], v22 offset:7680
    s_waitcnt lgkmcnt(8)
    v_mfma_f32_32x32x16_bf16 v[104:119], a[16:19], a[48:51], v[104:119]
    ds_read_b64_tr_b16 a[0:1], v23 offset:7168
    ds_read_b64_tr_b16 a[2:3], v23 offset:7680
    s_add_u32 m0, s49, 3072
    s_add_u32 s62, s62, 393216
    buffer_load_dwordx4 v10, s[24:27], s62 offen offset:0 nt lds
    v_mfma_f32_32x32x16_bf16 v[120:135], a[20:23], a[48:51], v[120:135]
    ds_read_b64_tr_b16 a[4:5], v24 offset:7168
    ds_read_b64_tr_b16 a[6:7], v24 offset:7680
    s_waitcnt lgkmcnt(8)
    v_mfma_f32_32x32x16_bf16 v[104:119], a[24:27], a[52:55], v[104:119]
    ds_read_b64_tr_b16 a[8:9], v21 offset:8192
    ds_read_b64_tr_b16 a[10:11], v21 offset:8704
    buffer_load_dwordx4 v11, s[24:27], s62 offen offset:1024 nt lds
    v_mfma_f32_32x32x16_bf16 v[120:135], a[28:31], a[52:55], v[120:135]
    ds_read_b64_tr_b16 a[12:13], v22 offset:8192
    ds_read_b64_tr_b16 a[14:15], v22 offset:8704
    buffer_load_dwordx4 v12, s[24:27], s62 offen offset:2048 nt lds
    s_waitcnt lgkmcnt(8)
    v_mfma_f32_32x32x16_bf16 v[40:55], a[32:35], a[56:59], v[40:55]
    ds_read_b64_tr_b16 a[16:17], v23 offset:8192
    ds_read_b64_tr_b16 a[18:19], v23 offset:8704
    v_mfma_f32_32x32x16_bf16 v[56:71], a[36:39], a[56:59], v[56:71]
    ds_read_b64_tr_b16 a[20:21], v24 offset:8192
    ds_read_b64_tr_b16 a[22:23], v24 offset:8704
    s_waitcnt lgkmcnt(8)
    v_mfma_f32_32x32x16_bf16 v[40:55], a[0:3], a[60:63], v[40:55]
    ds_read_b64_tr_b16 a[24:25], v21 offset:9216
    ds_read_b64_tr_b16 a[26:27], v21 offset:9728
    v_mfma_f32_32x32x16_bf16 v[56:71], a[4:7], a[60:63], v[56:71]
    ds_read_b64_tr_b16 a[28:29], v22 offset:9216
    ds_read_b64_tr_b16 a[30:31], v22 offset:9728
    s_waitcnt lgkmcnt(8)
    v_mfma_f32_32x32x16_bf16 v[72:87], a[8:11], a[56:59], v[72:87]
    ds_read_b64_tr_b16 a[32:33], v23 offset:9216
    ds_read_b64_tr_b16 a[34:35], v23 offset:9728
    v_mfma_f32_32x32x16_bf16 v[88:103], a[12:15], a[56:59], v[88:103]
    ds_read_b64_tr_b16 a[36:37], v24 offset:9216
    ds_read_b64_tr_b16 a[38:39], v24 offset:9728
    s_waitcnt vmcnt(28)
    ds_read_b128 a[64:67], v13 offset:10240
    ds_read_b128 a[68:71], v14 offset:10240
    s_waitcnt lgkmcnt(10)
    v_mfma_f32_32x32x16_bf16 v[72:87], a[16:19], a[60:63], v[72:87]
    s_waitcnt vmcnt(25)
    s_barrier
    ds_read_b64_tr_b16 a[0:1], v21 offset:14336
    ds_read_b64_tr_b16 a[2:3], v21 offset:14848
    ds_read_b128 a[72:75], v15 offset:10240
    v_mfma_f32_32x32x16_bf16 v[88:103], a[20:23], a[60:63], v[88:103]
    ds_read_b64_tr_b16 a[4:5], v22 offset:14336
    ds_read_b64_tr_b16 a[6:7], v22 offset:14848
    ds_read_b128 a[76:79], v16 offset:10240
    s_waitcnt lgkmcnt(12)
    v_mfma_f32_32x32x16_bf16 v[104:119], a[24:27], a[56:59], v[104:119]
    ds_read_b64_tr_b16 a[8:9], v23 offset:14336
    ds_read_b64_tr_b16 a[10:11], v23 offset:14848
    v_mfma_f32_32x32x16_bf16 v[120:135], a[28:31], a[56:59], v[120:135]
    ds_read_b64_tr_b16 a[12:13], v24 offset:14336
    ds_read_b64_tr_b16 a[14:15], v24 offset:14848
    s_waitcnt lgkmcnt(12)
    v_mfma_f32_32x32x16_bf16 v[104:119], a[32:35], a[60:63], v[104:119]
    ds_read_b64_tr_b16 a[16:17], v21 offset:15360
    ds_read_b64_tr_b16 a[18:19], v21 offset:15872
    v_mfma_f32_32x32x16_bf16 v[120:135], a[36:39], a[60:63], v[120:135]
    ds_read_b64_tr_b16 a[20:21], v22 offset:15360
    ds_read_b64_tr_b16 a[22:23], v22 offset:15872
    s_waitcnt lgkmcnt(9)
    v_mfma_f32_32x32x16_bf16 v[40:55], a[0:3], a[64:67], v[40:55]
    ds_read_b64_tr_b16 a[24:25], v23 offset:15360
    ds_read_b64_tr_b16 a[26:27], v23 offset:15872
    v_mfma_f32_32x32x16_bf16 v[56:71], a[4:7], a[64:67], v[56:71]
    ds_read_b64_tr_b16 a[28:29], v24 offset:15360
    ds_read_b64_tr_b16 a[30:31], v24 offset:15872
    s_waitcnt lgkmcnt(8)
    v_mfma_f32_32x32x16_bf16 v[40:55], a[8:11], a[68:71], v[40:55]
    ds_read_b64_tr_b16 a[32:33], v21 offset:16384
    ds_read_b64_tr_b16 a[34:35], v21 offset:16896
    s_add_u32 m0, s49, 10240
    s_and_b32 s51, s50, 128
    s_xor_b32 s51, s51, 1024
    buffer_load_dwordx4 v6, s[20:23], s51 offen offset:0 lds
    v_mfma_f32_32x32x16_bf16 v[56:71], a[12:15], a[68:71], v[56:71]
    ds_read_b64_tr_b16 a[36:37], v22 offset:16384
    ds_read_b64_tr_b16 a[38:39], v22 offset:16896
    s_waitcnt lgkmcnt(8)
    v_mfma_f32_32x32x16_bf16 v[72:87], a[16:19], a[64:67], v[72:87]
    ds_read_b64_tr_b16 a[0:1], v23 offset:16384
    ds_read_b64_tr_b16 a[2:3], v23 offset:16896
    v_mfma_f32_32x32x16_bf16 v[88:103], a[20:23], a[64:67], v[88:103]
    ds_read_b64_tr_b16 a[4:5], v24 offset:16384
    ds_read_b64_tr_b16 a[6:7], v24 offset:16896
    buffer_load_dwordx4 v7, s[20:23], s51 offen offset:1024 lds
    s_waitcnt lgkmcnt(8)
    v_mfma_f32_32x32x16_bf16 v[72:87], a[24:27], a[68:71], v[72:87]
    s_waitcnt vmcnt(24)
    s_barrier
    ds_read_b64_tr_b16 a[8:9], v21 offset:17408
    ds_read_b64_tr_b16 a[10:11], v21 offset:17920
    v_mfma_f32_32x32x16_bf16 v[88:103], a[28:31], a[68:71], v[88:103]
    ds_read_b64_tr_b16 a[12:13], v22 offset:17408
    ds_read_b64_tr_b16 a[14:15], v22 offset:17920
    s_waitcnt lgkmcnt(8)
    v_mfma_f32_32x32x16_bf16 v[104:119], a[32:35], a[64:67], v[104:119]
    ds_read_b64_tr_b16 a[16:17], v23 offset:17408
    ds_read_b64_tr_b16 a[18:19], v23 offset:17920
    buffer_load_dwordx4 v8, s[20:23], s51 offen offset:2048 lds
    v_mfma_f32_32x32x16_bf16 v[120:135], a[36:39], a[64:67], v[120:135]
    ds_read_b64_tr_b16 a[20:21], v24 offset:17408
    ds_read_b64_tr_b16 a[22:23], v24 offset:17920
    s_waitcnt lgkmcnt(8)
    v_mfma_f32_32x32x16_bf16 v[104:119], a[0:3], a[68:71], v[104:119]
    ds_read_b64_tr_b16 a[24:25], v21 offset:18432
    ds_read_b64_tr_b16 a[26:27], v21 offset:18944
    v_mfma_f32_32x32x16_bf16 v[120:135], a[4:7], a[68:71], v[120:135]
    ds_read_b64_tr_b16 a[28:29], v22 offset:18432
    ds_read_b64_tr_b16 a[30:31], v22 offset:18944
    buffer_load_dwordx4 v9, s[20:23], s51 offen offset:3072 lds
    s_waitcnt lgkmcnt(8)
    v_mfma_f32_32x32x16_bf16 v[40:55], a[8:11], a[72:75], v[40:55]
    ds_read_b64_tr_b16 a[32:33], v23 offset:18432
    ds_read_b64_tr_b16 a[34:35], v23 offset:18944
    v_mfma_f32_32x32x16_bf16 v[56:71], a[12:15], a[72:75], v[56:71]
    ds_read_b64_tr_b16 a[36:37], v24 offset:18432
    ds_read_b64_tr_b16 a[38:39], v24 offset:18944
    s_add_u32 m0, s49, 27648
    s_mul_i32 s62, s51, 6144
    buffer_load_dwordx4 v10, s[24:27], s62 offen offset:0 lds
    s_waitcnt lgkmcnt(8)
    v_mfma_f32_32x32x16_bf16 v[40:55], a[16:19], a[76:79], v[40:55]
    ds_read_b64_tr_b16 a[0:1], v21 offset:19456
    ds_read_b64_tr_b16 a[2:3], v21 offset:19968
    v_mfma_f32_32x32x16_bf16 v[56:71], a[20:23], a[76:79], v[56:71]
    ds_read_b64_tr_b16 a[4:5], v22 offset:19456
    ds_read_b64_tr_b16 a[6:7], v22 offset:19968
    s_waitcnt lgkmcnt(8)
    v_mfma_f32_32x32x16_bf16 v[72:87], a[24:27], a[72:75], v[72:87]
    ds_read_b64_tr_b16 a[8:9], v23 offset:19456
    ds_read_b64_tr_b16 a[10:11], v23 offset:19968
    buffer_load_dwordx4 v11, s[24:27], s62 offen offset:1024 lds
    v_mfma_f32_32x32x16_bf16 v[88:103], a[28:31], a[72:75], v[88:103]
    ds_read_b64_tr_b16 a[12:13], v24 offset:19456
    ds_read_b64_tr_b16 a[14:15], v24 offset:19968
    s_waitcnt vmcnt(24)
    ds_read_b128 a[48:51], v13 offset:20480
    ds_read_b128 a[52:55], v14 offset:20480
    s_waitcnt lgkmcnt(10)
    v_mfma_f32_32x32x16_bf16 v[72:87], a[32:35], a[76:79], v[72:87]
    s_waitcnt vmcnt(21)
    s_barrier
    ds_read_b64_tr_b16 a[16:17], v21 offset:24576
    ds_read_b64_tr_b16 a[18:19], v21 offset:25088
    ds_read_b128 a[56:59], v15 offset:20480
    v_mfma_f32_32x32x16_bf16 v[88:103], a[36:39], a[76:79], v[88:103]
    ds_read_b64_tr_b16 a[20:21], v22 offset:24576
    ds_read_b64_tr_b16 a[22:23], v22 offset:25088
    buffer_load_dwordx4 v12, s[24:27], s62 offen offset:2048 lds
    ds_read_b128 a[60:63], v16 offset:20480
    s_waitcnt lgkmcnt(12)
    v_mfma_f32_32x32x16_bf16 v[104:119], a[0:3], a[72:75], v[104:119]
    ds_read_b64_tr_b16 a[24:25], v23 offset:24576
    ds_read_b64_tr_b16 a[26:27], v23 offset:25088
    v_mfma_f32_32x32x16_bf16 v[120:135], a[4:7], a[72:75], v[120:135]
    ds_read_b64_tr_b16 a[28:29], v24 offset:24576
    ds_read_b64_tr_b16 a[30:31], v24 offset:25088
    s_waitcnt lgkmcnt(12)
    v_mfma_f32_32x32x16_bf16 v[104:119], a[8:11], a[76:79], v[104:119]
    ds_read_b64_tr_b16 a[32:33], v21 offset:25600
    ds_read_b64_tr_b16 a[34:35], v21 offset:26112
    s_add_u32 m0, s49, 37888
    s_add_u32 s62, s62, 393216
    buffer_load_dwordx4 v10, s[24:27], s62 offen offset:0 lds
    v_mfma_f32_32x32x16_bf16 v[120:135], a[12:15], a[76:79], v[120:135]
    ds_read_b64_tr_b16 a[36:37], v22 offset:25600
    ds_read_b64_tr_b16 a[38:39], v22 offset:26112
    s_waitcnt lgkmcnt(9)
    v_mfma_f32_32x32x16_bf16 v[40:55], a[16:19], a[48:51], v[40:55]
    ds_read_b64_tr_b16 a[0:1], v23 offset:25600
    ds_read_b64_tr_b16 a[2:3], v23 offset:26112
    buffer_load_dwordx4 v11, s[24:27], s62 offen offset:1024 lds
    v_mfma_f32_32x32x16_bf16 v[56:71], a[20:23], a[48:51], v[56:71]
    ds_read_b64_tr_b16 a[4:5], v24 offset:25600
    ds_read_b64_tr_b16 a[6:7], v24 offset:26112
    s_waitcnt lgkmcnt(8)
    v_mfma_f32_32x32x16_bf16 v[40:55], a[24:27], a[52:55], v[40:55]
    ds_read_b64_tr_b16 a[8:9], v21 offset:26624
    ds_read_b64_tr_b16 a[10:11], v21 offset:27136
    v_mfma_f32_32x32x16_bf16 v[56:71], a[28:31], a[52:55], v[56:71]
    ds_read_b64_tr_b16 a[12:13], v22 offset:26624
    ds_read_b64_tr_b16 a[14:15], v22 offset:27136
    buffer_load_dwordx4 v12, s[24:27], s62 offen offset:2048 lds
    s_waitcnt lgkmcnt(8)
    v_mfma_f32_32x32x16_bf16 v[72:87], a[32:35], a[48:51], v[72:87]
    ds_read_b64_tr_b16 a[16:17], v23 offset:26624
    ds_read_b64_tr_b16 a[18:19], v23 offset:27136
    v_mfma_f32_32x32x16_bf16 v[88:103], a[36:39], a[48:51], v[88:103]
    ds_read_b64_tr_b16 a[20:21], v24 offset:26624
    ds_read_b64_tr_b16 a[22:23], v24 offset:27136
    s_waitcnt lgkmcnt(8)
    v_mfma_f32_32x32x16_bf16 v[72:87], a[0:3], a[52:55], v[72:87]
    s_waitcnt vmcnt(22)
    s_barrier
    ds_read_b64_tr_b16 a[24:25], v21 offset:30720
    ds_read_b64_tr_b16 a[26:27], v21 offset:31232
    s_add_u32 m0, s49, 6144
    s_and_b32 s51, s50, 128
    s_xor_b32 s51, s51, 1152
    buffer_load_dwordx4 v6, s[20:23], s51 offen offset:0 nt lds
    v_mfma_f32_32x32x16_bf16 v[88:103], a[4:7], a[52:55], v[88:103]
    ds_read_b64_tr_b16 a[28:29], v22 offset:30720
    ds_read_b64_tr_b16 a[30:31], v22 offset:31232
    s_waitcnt lgkmcnt(8)
    v_mfma_f32_32x32x16_bf16 v[104:119], a[8:11], a[48:51], v[104:119]
    ds_read_b64_tr_b16 a[32:33], v23 offset:30720
    ds_read_b64_tr_b16 a[34:35], v23 offset:31232
    v_mfma_f32_32x32x16_bf16 v[120:135], a[12:15], a[48:51], v[120:135]
    ds_read_b64_tr_b16 a[36:37], v24 offset:30720
    ds_read_b64_tr_b16 a[38:39], v24 offset:31232
    buffer_load_dwordx4 v7, s[20:23], s51 offen offset:1024 nt lds
    s_waitcnt lgkmcnt(8)
    v_mfma_f32_32x32x16_bf16 v[104:119], a[16:19], a[52:55], v[104:119]
    ds_read_b64_tr_b16 a[0:1], v21 offset:31744
    ds_read_b64_tr_b16 a[2:3], v21 offset:32256
    v_mfma_f32_32x32x16_bf16 v[120:135], a[20:23], a[52:55], v[120:135]
    ds_read_b64_tr_b16 a[4:5], v22 offset:31744
    ds_read_b64_tr_b16 a[6:7], v22 offset:32256
    s_waitcnt lgkmcnt(8)
    v_mfma_f32_32x32x16_bf16 v[40:55], a[24:27], a[56:59], v[40:55]
    ds_read_b64_tr_b16 a[8:9], v23 offset:31744
    ds_read_b64_tr_b16 a[10:11], v23 offset:32256
    buffer_load_dwordx4 v8, s[20:23], s51 offen offset:2048 nt lds
    v_mfma_f32_32x32x16_bf16 v[56:71], a[28:31], a[56:59], v[56:71]
    ds_read_b64_tr_b16 a[12:13], v24 offset:31744
    ds_read_b64_tr_b16 a[14:15], v24 offset:32256
    s_waitcnt lgkmcnt(8)
    v_mfma_f32_32x32x16_bf16 v[40:55], a[32:35], a[60:63], v[40:55]
    ds_read_b64_tr_b16 a[16:17], v21 offset:32768
    ds_read_b64_tr_b16 a[18:19], v21 offset:33280
    buffer_load_dwordx4 v9, s[20:23], s51 offen offset:3072 nt lds
    v_mfma_f32_32x32x16_bf16 v[56:71], a[36:39], a[60:63], v[56:71]
    ds_read_b64_tr_b16 a[20:21], v22 offset:32768
    ds_read_b64_tr_b16 a[22:23], v22 offset:33280
    s_waitcnt lgkmcnt(8)
    v_mfma_f32_32x32x16_bf16 v[72:87], a[0:3], a[56:59], v[72:87]
    ds_read_b64_tr_b16 a[24:25], v23 offset:32768
    ds_read_b64_tr_b16 a[26:27], v23 offset:33280
    v_mfma_f32_32x32x16_bf16 v[88:103], a[4:7], a[56:59], v[88:103]
    ds_read_b64_tr_b16 a[28:29], v24 offset:32768
    ds_read_b64_tr_b16 a[30:31], v24 offset:33280
    s_waitcnt vmcnt(22)
    ds_read_b128 a[64:67], v13 offset:33792
    s_add_u32 m0, s49, 14336
    s_mul_i32 s62, s51, 6144
    buffer_load_dwordx4 v10, s[24:27], s62 offen offset:0 nt lds
    s_waitcnt lgkmcnt(9)
    v_mfma_f32_32x32x16_bf16 v[72:87], a[8:11], a[60:63], v[72:87]
    s_waitcnt vmcnt(18)
    s_barrier
    ds_read_b64_tr_b16 a[32:33], v21 offset:0
    ds_read_b64_tr_b16 a[34:35], v21 offset:512
    ds_read_b128 a[68:71], v14 offset:33792
    ds_read_b128 a[72:75], v15 offset:33792
    v_mfma_f32_32x32x16_bf16 v[88:103], a[12:15], a[60:63], v[88:103]
    ds_read_b64_tr_b16 a[36:37], v22 offset:0
    ds_read_b64_tr_b16 a[38:39], v22 offset:512
    ds_read_b128 a[76:79], v16 offset:33792
    s_waitcnt lgkmcnt(12)
    v_mfma_f32_32x32x16_bf16 v[104:119], a[16:19], a[56:59], v[104:119]
    ds_read_b64_tr_b16 a[0:1], v23 offset:0
    ds_read_b64_tr_b16 a[2:3], v23 offset:512
    buffer_load_dwordx4 v11, s[24:27], s62 offen offset:1024 nt lds
    v_mfma_f32_32x32x16_bf16 v[120:135], a[20:23], a[56:59], v[120:135]
    ds_read_b64_tr_b16 a[4:5], v24 offset:0
    ds_read_b64_tr_b16 a[6:7], v24 offset:512
    s_waitcnt lgkmcnt(12)
    v_mfma_f32_32x32x16_bf16 v[104:119], a[24:27], a[60:63], v[104:119]
    ds_read_b64_tr_b16 a[8:9], v21 offset:1024
    ds_read_b64_tr_b16 a[10:11], v21 offset:1536
    v_mfma_f32_32x32x16_bf16 v[120:135], a[28:31], a[60:63], v[120:135]
    ds_read_b64_tr_b16 a[12:13], v22 offset:1024
    ds_read_b64_tr_b16 a[14:15], v22 offset:1536
    buffer_load_dwordx4 v12, s[24:27], s62 offen offset:2048 nt lds
    s_waitcnt lgkmcnt(9)
    v_mfma_f32_32x32x16_bf16 v[40:55], a[32:35], a[64:67], v[40:55]
    ds_read_b64_tr_b16 a[16:17], v23 offset:1024
    ds_read_b64_tr_b16 a[18:19], v23 offset:1536
    v_mfma_f32_32x32x16_bf16 v[56:71], a[36:39], a[64:67], v[56:71]
    ds_read_b64_tr_b16 a[20:21], v24 offset:1024
    ds_read_b64_tr_b16 a[22:23], v24 offset:1536
    s_add_u32 m0, s49, 17408
    s_add_u32 s62, s62, 393216
    buffer_load_dwordx4 v10, s[24:27], s62 offen offset:0 nt lds
    s_waitcnt lgkmcnt(8)
    v_mfma_f32_32x32x16_bf16 v[40:55], a[0:3], a[68:71], v[40:55]
    ds_read_b64_tr_b16 a[24:25], v21 offset:2048
    ds_read_b64_tr_b16 a[26:27], v21 offset:2560
    v_mfma_f32_32x32x16_bf16 v[56:71], a[4:7], a[68:71], v[56:71]
    ds_read_b64_tr_b16 a[28:29], v22 offset:2048
    ds_read_b64_tr_b16 a[30:31], v22 offset:2560
    s_waitcnt lgkmcnt(8)
    v_mfma_f32_32x32x16_bf16 v[72:87], a[8:11], a[64:67], v[72:87]
    ds_read_b64_tr_b16 a[32:33], v23 offset:2048
    ds_read_b64_tr_b16 a[34:35], v23 offset:2560
    buffer_load_dwordx4 v11, s[24:27], s62 offen offset:1024 nt lds
    v_mfma_f32_32x32x16_bf16 v[88:103], a[12:15], a[64:67], v[88:103]
    ds_read_b64_tr_b16 a[36:37], v24 offset:2048
    ds_read_b64_tr_b16 a[38:39], v24 offset:2560
    s_waitcnt lgkmcnt(8)
    v_mfma_f32_32x32x16_bf16 v[72:87], a[16:19], a[68:71], v[72:87]
    s_waitcnt vmcnt(19)
    s_barrier
    ds_read_b64_tr_b16 a[0:1], v21 offset:3072
    ds_read_b64_tr_b16 a[2:3], v21 offset:3584
    v_mfma_f32_32x32x16_bf16 v[88:103], a[20:23], a[68:71], v[88:103]
    ds_read_b64_tr_b16 a[4:5], v22 offset:3072
    ds_read_b64_tr_b16 a[6:7], v22 offset:3584
    buffer_load_dwordx4 v12, s[24:27], s62 offen offset:2048 nt lds
    s_waitcnt lgkmcnt(8)
    v_mfma_f32_32x32x16_bf16 v[104:119], a[24:27], a[64:67], v[104:119]
    ds_read_b64_tr_b16 a[8:9], v23 offset:3072
    ds_read_b64_tr_b16 a[10:11], v23 offset:3584
    v_mfma_f32_32x32x16_bf16 v[120:135], a[28:31], a[64:67], v[120:135]
    ds_read_b64_tr_b16 a[12:13], v24 offset:3072
    ds_read_b64_tr_b16 a[14:15], v24 offset:3584
    s_waitcnt lgkmcnt(8)
    v_mfma_f32_32x32x16_bf16 v[104:119], a[32:35], a[68:71], v[104:119]
    ds_read_b64_tr_b16 a[16:17], v21 offset:4096
    ds_read_b64_tr_b16 a[18:19], v21 offset:4608
    s_add_u32 m0, s49, 20480
    s_mov_b32 s63, 0
    buffer_load_dwordx4 v2, s[28:31], s63 offen offset:0 nt lds
    v_mfma_f32_32x32x16_bf16 v[120:135], a[36:39], a[68:71], v[120:135]
    ds_read_b64_tr_b16 a[20:21], v22 offset:4096
    ds_read_b64_tr_b16 a[22:23], v22 offset:4608
    s_waitcnt lgkmcnt(8)
    v_mfma_f32_32x32x16_bf16 v[40:55], a[0:3], a[72:75], v[40:55]
    ds_read_b64_tr_b16 a[24:25], v23 offset:4096
    ds_read_b64_tr_b16 a[26:27], v23 offset:4608
    buffer_load_dwordx4 v3, s[28:31], s63 offen offset:1024 nt lds
    v_mfma_f32_32x32x16_bf16 v[56:71], a[4:7], a[72:75], v[56:71]
    ds_read_b64_tr_b16 a[28:29], v24 offset:4096
    ds_read_b64_tr_b16 a[30:31], v24 offset:4608
    s_waitcnt lgkmcnt(8)
    v_mfma_f32_32x32x16_bf16 v[40:55], a[8:11], a[76:79], v[40:55]
    ds_read_b64_tr_b16 a[32:33], v21 offset:5120
    ds_read_b64_tr_b16 a[34:35], v21 offset:5632
    v_mfma_f32_32x32x16_bf16 v[56:71], a[12:15], a[76:79], v[56:71]
    ds_read_b64_tr_b16 a[36:37], v22 offset:5120
    ds_read_b64_tr_b16 a[38:39], v22 offset:5632
    buffer_load_dwordx4 v4, s[28:31], s63 offen offset:2048 nt lds
    s_waitcnt lgkmcnt(8)
    v_mfma_f32_32x32x16_bf16 v[72:87], a[16:19], a[72:75], v[72:87]
    ds_read_b64_tr_b16 a[0:1], v23 offset:5120
    ds_read_b64_tr_b16 a[2:3], v23 offset:5632
    v_mfma_f32_32x32x16_bf16 v[88:103], a[20:23], a[72:75], v[88:103]
    ds_read_b64_tr_b16 a[4:5], v24 offset:5120
    ds_read_b64_tr_b16 a[6:7], v24 offset:5632
    s_waitcnt vmcnt(19)
    ds_read_b128 a[48:51], v13 offset:10240
    ds_read_b128 a[52:55], v14 offset:10240
    s_waitcnt lgkmcnt(10)
    v_mfma_f32_32x32x16_bf16 v[72:87], a[24:27], a[76:79], v[72:87]
    s_waitcnt vmcnt(16)
    s_barrier
    ds_read_b64_tr_b16 a[8:9], v21 offset:27648
    ds_read_b64_tr_b16 a[10:11], v21 offset:28160
    buffer_load_dwordx4 v5, s[28:31], s63 offen offset:3072 nt lds
    v_mfma_f32_32x32x16_bf16 v[88:103], a[28:31], a[76:79], v[88:103]
    ds_read_b64_tr_b16 a[12:13], v22 offset:27648
    ds_read_b64_tr_b16 a[14:15], v22 offset:28160
    ds_read_b128 a[56:59], v15 offset:10240
    ds_read_b128 a[60:63], v16 offset:10240
    s_waitcnt lgkmcnt(12)
    v_mfma_f32_32x32x16_bf16 v[104:119], a[32:35], a[72:75], v[104:119]
    ds_read_b64_tr_b16 a[16:17], v23 offset:27648
    ds_read_b64_tr_b16 a[18:19], v23 offset:28160
    v_mfma_f32_32x32x16_bf16 v[120:135], a[36:39], a[72:75], v[120:135]
    ds_read_b64_tr_b16 a[20:21], v24 offset:27648
    ds_read_b64_tr_b16 a[22:23], v24 offset:28160
    s_add_u32 m0, s49, 30720
    s_mov_b32 s63, 128
    buffer_load_dwordx4 v2, s[28:31], s63 offen offset:0 nt lds
    s_waitcnt lgkmcnt(12)
    v_mfma_f32_32x32x16_bf16 v[104:119], a[0:3], a[76:79], v[104:119]
    ds_read_b64_tr_b16 a[24:25], v21 offset:28672
    ds_read_b64_tr_b16 a[26:27], v21 offset:29184
    v_mfma_f32_32x32x16_bf16 v[120:135], a[4:7], a[76:79], v[120:135]
    ds_read_b64_tr_b16 a[28:29], v22 offset:28672
    ds_read_b64_tr_b16 a[30:31], v22 offset:29184
    buffer_load_dwordx4 v3, s[28:31], s63 offen offset:1024 nt lds
    s_waitcnt lgkmcnt(10)
    v_mfma_f32_32x32x16_bf16 v[40:55], a[8:11], a[48:51], v[40:55]
    ds_read_b64_tr_b16 a[32:33], v23 offset:28672
    ds_read_b64_tr_b16 a[34:35], v23 offset:29184
    v_mfma_f32_32x32x16_bf16 v[56:71], a[12:15], a[48:51], v[56:71]
    ds_read_b64_tr_b16 a[36:37], v24 offset:28672
    ds_read_b64_tr_b16 a[38:39], v24 offset:29184
    s_waitcnt lgkmcnt(8)
    v_mfma_f32_32x32x16_bf16 v[40:55], a[16:19], a[52:55], v[40:55]
    ds_read_b64_tr_b16 a[0:1], v21 offset:29696
    ds_read_b64_tr_b16 a[2:3], v21 offset:30208
    buffer_load_dwordx4 v4, s[28:31], s63 offen offset:2048 nt lds
    v_mfma_f32_32x32x16_bf16 v[56:71], a[20:23], a[52:55], v[56:71]
    ds_read_b64_tr_b16 a[4:5], v22 offset:29696
    ds_read_b64_tr_b16 a[6:7], v22 offset:30208
    s_waitcnt lgkmcnt(8)
    v_mfma_f32_32x32x16_bf16 v[72:87], a[24:27], a[48:51], v[72:87]
    ds_read_b64_tr_b16 a[8:9], v23 offset:29696
    ds_read_b64_tr_b16 a[10:11], v23 offset:30208
    v_mfma_f32_32x32x16_bf16 v[88:103], a[28:31], a[48:51], v[88:103]
    ds_read_b64_tr_b16 a[12:13], v24 offset:29696
    ds_read_b64_tr_b16 a[14:15], v24 offset:30208
    buffer_load_dwordx4 v5, s[28:31], s63 offen offset:3072 nt lds
    s_waitcnt lgkmcnt(8)
    v_mfma_f32_32x32x16_bf16 v[72:87], a[32:35], a[52:55], v[72:87]
    s_waitcnt vmcnt(18)
    s_barrier
    ds_read_b64_tr_b16 a[16:17], v21 offset:37888
    ds_read_b64_tr_b16 a[18:19], v21 offset:38400
    v_mfma_f32_32x32x16_bf16 v[88:103], a[36:39], a[52:55], v[88:103]
    ds_read_b64_tr_b16 a[20:21], v22 offset:37888
    ds_read_b64_tr_b16 a[22:23], v22 offset:38400
    s_waitcnt lgkmcnt(8)
    v_mfma_f32_32x32x16_bf16 v[104:119], a[0:3], a[48:51], v[104:119]
    ds_read_b64_tr_b16 a[24:25], v23 offset:37888
    ds_read_b64_tr_b16 a[26:27], v23 offset:38400
    s_add_u32 m0, s49, 0
    s_mov_b32 s63, 256
    buffer_load_dwordx4 v2, s[28:31], s63 offen offset:0 nt lds
    v_mfma_f32_32x32x16_bf16 v[120:135], a[4:7], a[48:51], v[120:135]
    ds_read_b64_tr_b16 a[28:29], v24 offset:37888
    ds_read_b64_tr_b16 a[30:31], v24 offset:38400
    s_waitcnt lgkmcnt(8)
    v_mfma_f32_32x32x16_bf16 v[104:119], a[8:11], a[52:55], v[104:119]
    ds_read_b64_tr_b16 a[32:33], v21 offset:38912
    ds_read_b64_tr_b16 a[34:35], v21 offset:39424
    v_mfma_f32_32x32x16_bf16 v[120:135], a[12:15], a[52:55], v[120:135]
    ds_read_b64_tr_b16 a[36:37], v22 offset:38912
    ds_read_b64_tr_b16 a[38:39], v22 offset:39424
    buffer_load_dwordx4 v3, s[28:31], s63 offen offset:1024 nt lds
    s_waitcnt lgkmcnt(8)
    v_mfma_f32_32x32x16_bf16 v[40:55], a[16:19], a[56:59], v[40:55]
    ds_read_b64_tr_b16 a[0:1], v23 offset:38912
    ds_read_b64_tr_b16 a[2:3], v23 offset:39424
    v_mfma_f32_32x32x16_bf16 v[56:71], a[20:23], a[56:59], v[56:71]
    ds_read_b64_tr_b16 a[4:5], v24 offset:38912
    ds_read_b64_tr_b16 a[6:7], v24 offset:39424
    buffer_load_dwordx4 v4, s[28:31], s63 offen offset:2048 nt lds
    s_waitcnt lgkmcnt(8)
    v_mfma_f32_32x32x16_bf16 v[40:55], a[24:27], a[60:63], v[40:55]
    ds_read_b64_tr_b16 a[8:9], v21 offset:39936
    ds_read_b64_tr_b16 a[10:11], v21 offset:40448
    v_mfma_f32_32x32x16_bf16 v[56:71], a[28:31], a[60:63], v[56:71]
    ds_read_b64_tr_b16 a[12:13], v22 offset:39936
    ds_read_b64_tr_b16 a[14:15], v22 offset:40448
    s_waitcnt lgkmcnt(8)
    v_mfma_f32_32x32x16_bf16 v[72:87], a[32:35], a[56:59], v[72:87]
    ds_read_b64_tr_b16 a[16:17], v23 offset:39936
    ds_read_b64_tr_b16 a[18:19], v23 offset:40448
    buffer_load_dwordx4 v5, s[28:31], s63 offen offset:3072 nt lds
    v_mfma_f32_32x32x16_bf16 v[88:103], a[36:39], a[56:59], v[88:103]
    ds_read_b64_tr_b16 a[20:21], v24 offset:39936
    ds_read_b64_tr_b16 a[22:23], v24 offset:40448
    s_waitcnt vmcnt(18)
    ds_read_b128 a[64:67], v13 offset:6144
    ds_read_b128 a[68:71], v14 offset:6144
    s_waitcnt lgkmcnt(10)
    v_mfma_f32_32x32x16_bf16 v[72:87], a[0:3], a[60:63], v[72:87]
    s_waitcnt vmcnt(12)
    s_barrier
    ds_read_b64_tr_b16 a[24:25], v21 offset:14336
    ds_read_b64_tr_b16 a[26:27], v21 offset:14848
    ds_read_b128 a[72:75], v15 offset:6144
    v_mfma_f32_32x32x16_bf16 v[88:103], a[4:7], a[60:63], v[88:103]
    ds_read_b64_tr_b16 a[28:29], v22 offset:14336
    ds_read_b64_tr_b16 a[30:31], v22 offset:14848
    ds_read_b128 a[76:79], v16 offset:6144
    s_waitcnt lgkmcnt(12)
    v_mfma_f32_32x32x16_bf16 v[104:119], a[8:11], a[56:59], v[104:119]
    ds_read_b64_tr_b16 a[32:33], v23 offset:14336
    ds_read_b64_tr_b16 a[34:35], v23 offset:14848
    v_mfma_f32_32x32x16_bf16 v[120:135], a[12:15], a[56:59], v[120:135]
    ds_read_b64_tr_b16 a[36:37], v24 offset:14336
    ds_read_b64_tr_b16 a[38:39], v24 offset:14848
    s_waitcnt lgkmcnt(12)
    v_mfma_f32_32x32x16_bf16 v[104:119], a[16:19], a[60:63], v[104:119]
    ds_read_b64_tr_b16 a[0:1], v21 offset:17408
    ds_read_b64_tr_b16 a[2:3], v21 offset:17920
    v_mfma_f32_32x32x16_bf16 v[120:135], a[20:23], a[60:63], v[120:135]
    ds_read_b64_tr_b16 a[4:5], v22 offset:17408
    ds_read_b64_tr_b16 a[6:7], v22 offset:17920
    s_waitcnt lgkmcnt(9)
    v_mfma_f32_32x32x16_bf16 v[40:55], a[24:27], a[64:67], v[40:55]
    ds_read_b64_tr_b16 a[8:9], v23 offset:17408
    ds_read_b64_tr_b16 a[10:11], v23 offset:17920
    v_mfma_f32_32x32x16_bf16 v[56:71], a[28:31], a[64:67], v[56:71]
    ds_read_b64_tr_b16 a[12:13], v24 offset:17408
    ds_read_b64_tr_b16 a[14:15], v24 offset:17920
    s_waitcnt vmcnt(8)
    ds_read_b128 a[80:83], v13 offset:20480
    ds_read_b128 a[84:87], v14 offset:20480
    s_waitcnt lgkmcnt(10)
    v_mfma_f32_32x32x16_bf16 v[40:55], a[32:35], a[68:71], v[40:55]
    ds_read_b64_tr_b16 a[16:17], v21 offset:15360
    ds_read_b64_tr_b16 a[18:19], v21 offset:15872
    ds_read_b128 a[88:91], v15 offset:20480
    v_mfma_f32_32x32x16_bf16 v[56:71], a[36:39], a[68:71], v[56:71]
    ds_read_b64_tr_b16 a[20:21], v22 offset:15360
    ds_read_b64_tr_b16 a[22:23], v22 offset:15872
    ds_read_b128 a[92:95], v16 offset:20480
    s_waitcnt lgkmcnt(12)
    v_mfma_f32_32x32x16_bf16 v[40:55], a[0:3], a[72:75], v[40:55]
    ds_read_b64_tr_b16 a[24:25], v23 offset:15360
    ds_read_b64_tr_b16 a[26:27], v23 offset:15872
    v_mfma_f32_32x32x16_bf16 v[56:71], a[4:7], a[72:75], v[56:71]
    ds_read_b64_tr_b16 a[28:29], v24 offset:15360
    ds_read_b64_tr_b16 a[30:31], v24 offset:15872
    s_waitcnt lgkmcnt(12)
    v_mfma_f32_32x32x16_bf16 v[40:55], a[8:11], a[76:79], v[40:55]
    ds_read_b64_tr_b16 a[32:33], v21 offset:18432
    ds_read_b64_tr_b16 a[34:35], v21 offset:18944
    v_mfma_f32_32x32x16_bf16 v[56:71], a[12:15], a[76:79], v[56:71]
    ds_read_b64_tr_b16 a[36:37], v22 offset:18432
    ds_read_b64_tr_b16 a[38:39], v22 offset:18944
    s_waitcnt lgkmcnt(9)
    v_mfma_f32_32x32x16_bf16 v[72:87], a[16:19], a[64:67], v[72:87]
    ds_read_b64_tr_b16 a[0:1], v23 offset:18432
    ds_read_b64_tr_b16 a[2:3], v23 offset:18944
    v_mfma_f32_32x32x16_bf16 v[88:103], a[20:23], a[64:67], v[88:103]
    s_branch .LskA2
.p2align 12
.LstA2:
    s_branch .LmA
.LskA2:
    ds_read_b64_tr_b16 a[4:5], v24 offset:18432
    ds_read_b64_tr_b16 a[6:7], v24 offset:18944
    s_waitcnt vmcnt(4)
    ds_read_b128 a[96:99], v13 offset:30720
    ds_read_b128 a[100:103], v14 offset:30720
    v_cvt_pk_bf16_f32 v40, v40, v41
    s_waitcnt lgkmcnt(10)
    v_mfma_f32_32x32x16_bf16 v[72:87], a[24:27], a[68:71], v[72:87]
    ds_read_b64_tr_b16 a[8:9], v21 offset:16384
    ds_read_b64_tr_b16 a[10:11], v21 offset:16896
    ds_read_b128 a[104:107], v15 offset:30720
    v_cvt_pk_bf16_f32 v41, v42, v43
    v_cvt_pk_bf16_f32 v42, v44, v45
    v_cvt_pk_bf16_f32 v43, v46, v47
    v_mfma_f32_32x32x16_bf16 v[88:103], a[28:31], a[68:71], v[88:103]
    ds_read_b64_tr_b16 a[12:13], v22 offset:16384
    ds_read_b64_tr_b16 a[14:15], v22 offset:16896
    ds_read_b128 a[108:111], v16 offset:30720
    v_cvt_pk_bf16_f32 v44, v48, v49
    v_cvt_pk_bf16_f32 v45, v50, v51
    v_cvt_pk_bf16_f32 v46, v52, v53
    s_waitcnt lgkmcnt(12)
    v_mfma_f32_32x32x16_bf16 v[72:87], a[32:35], a[72:75], v[72:87]
    ds_read_b64_tr_b16 a[16:17], v23 offset:16384
    ds_read_b64_tr_b16 a[18:19], v23 offset:16896
    v_cvt_pk_bf16_f32 v47, v54, v55
    v_cvt_pk_bf16_f32 v56, v56, v57
    v_cvt_pk_bf16_f32 v57, v58, v59
    v_cvt_pk_bf16_f32 v58, v60, v61
    v_mfma_f32_32x32x16_bf16 v[88:103], a[36:39], a[72:75], v[88:103]
    ds_read_b64_tr_b16 a[20:21], v24 offset:16384
    ds_read_b64_tr_b16 a[22:23], v24 offset:16896
    v_cvt_pk_bf16_f32 v59, v62, v63
    v_cvt_pk_bf16_f32 v60, v64, v65
    v_cvt_pk_bf16_f32 v61, v66, v67
    v_cvt_pk_bf16_f32 v62, v68, v69
    s_waitcnt lgkmcnt(12)
    v_mfma_f32_32x32x16_bf16 v[72:87], a[0:3], a[76:79], v[72:87]
    ds_read_b64_tr_b16 a[24:25], v21 offset:19456
    ds_read_b64_tr_b16 a[26:27], v21 offset:19968
    v_cvt_pk_bf16_f32 v63, v70, v71
    v_mfma_f32_32x32x16_bf16 v[136:151], a[80:83], v[40:43], 0
    v_mfma_f32_32x32x16_bf16 v[136:151], a[84:87], v[44:47], v[136:151]
    v_mfma_f32_32x32x16_bf16 v[136:151], a[88:91], v[56:59], v[136:151]
    v_mfma_f32_32x32x16_bf16 v[136:151], a[92:95], v[60:63], v[136:151]
    v_mfma_f32_32x32x16_bf16 v[88:103], a[4:7], a[76:79], v[88:103]
    ds_read_b64_tr_b16 a[28:29], v22 offset:19456
    ds_read_b64_tr_b16 a[30:31], v22 offset:19968
    s_waitcnt lgkmcnt(9)
    v_mfma_f32_32x32x16_bf16 v[104:119], a[8:11], a[64:67], v[104:119]
    ds_read_b64_tr_b16 a[32:33], v23 offset:19456
    ds_read_b64_tr_b16 a[34:35], v23 offset:19968
    v_cvt_pk_bf16_f32 v72, v72, v73
    v_cvt_pk_bf16_f32 v73, v74, v75
    v_cvt_pk_bf16_f32 v74, v76, v77
    v_cvt_pk_bf16_f32 v75, v78, v79
    v_mfma_f32_32x32x16_bf16 v[120:135], a[12:15], a[64:67], v[120:135]
    ds_read_b64_tr_b16 a[36:37], v24 offset:19456
    ds_read_b64_tr_b16 a[38:39], v24 offset:19968
    s_waitcnt vmcnt(0)
    ds_read_b128 a[112:115], v13 offset:0
    ds_read_b128 a[116:119], v14 offset:0
    v_cvt_pk_bf16_f32 v76, v80, v81
    s_waitcnt lgkmcnt(10)
    v_mfma_f32_32x32x16_bf16 v[104:119], a[16:19], a[68:71], v[104:119]
    ds_read_b128 a[120:123], v15 offset:0
    v_cvt_pk_bf16_f32 v77, v82, v83
    v_cvt_pk_bf16_f32 v78, v84, v85
    v_cvt_pk_bf16_f32 v79, v86, v87
    v_cvt_pk_bf16_f32 v88, v88, v89
    v_cvt_pk_bf16_f32 v89, v90, v91
    v_mfma_f32_32x32x16_bf16 v[120:135], a[20:23], a[68:71], v[120:135]
    ds_read_b128 a[124:127], v16 offset:0
    v_cvt_pk_bf16_f32 v90, v92, v93
    v_cvt_pk_bf16_f32 v91, v94, v95
    v_cvt_pk_bf16_f32 v92, v96, v97
    v_cvt_pk_bf16_f32 v93, v98, v99
    v_cvt_pk_bf16_f32 v94, v100, v101
    s_waitcnt lgkmcnt(8)
    v_mfma_f32_32x32x16_bf16 v[104:119], a[24:27], a[72:75], v[104:119]
    v_cvt_pk_bf16_f32 v95, v102, v103
    v_mfma_f32_32x32x16_bf16 v[136:151], a[96:99], v[72:75], v[136:151]
    v_mfma_f32_32x32x16_bf16 v[136:151], a[100:103], v[76:79], v[136:151]
    v_mfma_f32_32x32x16_bf16 v[136:151], a[104:107], v[88:91], v[136:151]
    v_mfma_f32_32x32x16_bf16 v[136:151], a[108:111], v[92:95], v[136:151]
    v_mfma_f32_32x32x16_bf16 v[120:135], a[28:31], a[72:75], v[120:135]
    s_waitcnt lgkmcnt(4)
    v_mfma_f32_32x32x16_bf16 v[104:119], a[32:35], a[76:79], v[104:119]
    v_mfma_f32_32x32x16_bf16 v[120:135], a[36:39], a[76:79], v[120:135]
    s_nop 10
    v_cvt_pk_bf16_f32 v104, v104, v105
    v_cvt_pk_bf16_f32 v105, v106, v107
    v_cvt_pk_bf16_f32 v106, v108, v109
    v_cvt_pk_bf16_f32 v107, v110, v111
    v_cvt_pk_bf16_f32 v108, v112, v113
    v_cvt_pk_bf16_f32 v109, v114, v115
    v_cvt_pk_bf16_f32 v110, v116, v117
    v_cvt_pk_bf16_f32 v111, v118, v119
    s_waitcnt lgkmcnt(3)
    v_mfma_f32_32x32x16_bf16 v[136:151], a[112:115], v[104:107], v[136:151]
    s_waitcnt lgkmcnt(2)
    v_mfma_f32_32x32x16_bf16 v[136:151], a[116:119], v[108:111], v[136:151]
    v_cvt_pk_bf16_f32 v120, v120, v121
    v_cvt_pk_bf16_f32 v121, v122, v123
    v_cvt_pk_bf16_f32 v122, v124, v125
    v_cvt_pk_bf16_f32 v123, v126, v127
    v_cvt_pk_bf16_f32 v124, v128, v129
    v_cvt_pk_bf16_f32 v125, v130, v131
    v_cvt_pk_bf16_f32 v126, v132, v133
    v_cvt_pk_bf16_f32 v127, v134, v135
    s_waitcnt lgkmcnt(1)
    v_mfma_f32_32x32x16_bf16 v[136:151], a[120:123], v[120:123], v[136:151]
    s_waitcnt lgkmcnt(0)
    v_mfma_f32_32x32x16_bf16 v[136:151], a[124:127], v[124:127], v[136:151]
    s_nop 11
    v_max3_f32 v34, v136, v137, v138
    v_max3_f32 v36, v139, v140, v141
    v_max3_f32 v34, v34, v142, v143
    v_max3_f32 v36, v36, v144, v145
    v_max3_f32 v34, v34, v146, v147
    v_max3_f32 v36, v36, v148, v149
    v_max3_f32 v34, v34, v150, v151
    v_max_f32 v35, v34, v36
    v_max_f32 v34, v34, v36
    s_nop 1
    v_permlane32_swap_b32 v34, v35
    v_max_f32 v34, v34, v35
    v_mul_f32 v34, s52, v34
    v_pk_fma_f32 v[136:137], v[136:137], s[52:53], v[34:35] op_sel_hi:[1,0,0] neg_lo:[0,0,1] neg_hi:[0,0,1]
    v_pk_fma_f32 v[138:139], v[138:139], s[52:53], v[34:35] op_sel_hi:[1,0,0] neg_lo:[0,0,1] neg_hi:[0,0,1]
    v_pk_fma_f32 v[140:141], v[140:141], s[52:53], v[34:35] op_sel_hi:[1,0,0] neg_lo:[0,0,1] neg_hi:[0,0,1]
    v_pk_fma_f32 v[142:143], v[142:143], s[52:53], v[34:35] op_sel_hi:[1,0,0] neg_lo:[0,0,1] neg_hi:[0,0,1]
    v_pk_fma_f32 v[144:145], v[144:145], s[52:53], v[34:35] op_sel_hi:[1,0,0] neg_lo:[0,0,1] neg_hi:[0,0,1]
    v_pk_fma_f32 v[146:147], v[146:147], s[52:53], v[34:35] op_sel_hi:[1,0,0] neg_lo:[0,0,1] neg_hi:[0,0,1]
    v_pk_fma_f32 v[148:149], v[148:149], s[52:53], v[34:35] op_sel_hi:[1,0,0] neg_lo:[0,0,1] neg_hi:[0,0,1]
    v_pk_fma_f32 v[150:151], v[150:151], s[52:53], v[34:35] op_sel_hi:[1,0,0] neg_lo:[0,0,1] neg_hi:[0,0,1]
    v_exp_f32 v136, v136
    v_exp_f32 v137, v137
    v_exp_f32 v138, v138
    v_exp_f32 v139, v139
    v_exp_f32 v140, v140
    v_exp_f32 v141, v141
    v_pk_add_f32 v[34:35], v[136:137], v[138:139]
    v_exp_f32 v142, v142
    v_exp_f32 v143, v143
    v_pk_add_f32 v[34:35], v[34:35], v[140:141]
    v_exp_f32 v144, v144
    v_exp_f32 v145, v145
    v_pk_add_f32 v[34:35], v[34:35], v[142:143]
    v_exp_f32 v146, v146
    v_exp_f32 v147, v147
    v_pk_add_f32 v[34:35], v[34:35], v[144:145]
    v_exp_f32 v148, v148
    v_exp_f32 v149, v149
    v_pk_add_f32 v[34:35], v[34:35], v[146:147]
    v_exp_f32 v150, v150
    v_exp_f32 v151, v151
    v_pk_add_f32 v[34:35], v[34:35], v[148:149]
    v_pk_add_f32 v[34:35], v[34:35], v[150:151]
    v_add_f32 v36, v34, v35
    v_add_f32 v34, v34, v35
    s_nop 1
    v_permlane32_swap_b32 v34, v36
    v_add_f32 v34, v34, v36
    v_rcp_f32 v34, v34
    s_add_u32 s61, s32, 8192
    v_pk_mul_f32 v[136:137], v[136:137], v[34:35] op_sel_hi:[1,0]
    v_pk_mul_f32 v[138:139], v[138:139], v[34:35] op_sel_hi:[1,0]
    v_pk_mul_f32 v[140:141], v[140:141], v[34:35] op_sel_hi:[1,0]
    v_pk_mul_f32 v[142:143], v[142:143], v[34:35] op_sel_hi:[1,0]
    v_cvt_pk_bf16_f32 v152, v136, v137
    v_cvt_pk_bf16_f32 v153, v138, v139
    v_cvt_pk_bf16_f32 v154, v140, v141
    v_cvt_pk_bf16_f32 v155, v142, v143
    v_bfi_b32 v152, s54, v30, v152
    v_bfi_b32 v154, s54, v31, v154
    buffer_store_dwordx4 v[152:155], v0, s[40:43], s32 offen offset:0
    v_pk_mul_f32 v[144:145], v[144:145], v[34:35] op_sel_hi:[1,0]
    v_pk_mul_f32 v[146:147], v[146:147], v[34:35] op_sel_hi:[1,0]
    v_pk_mul_f32 v[148:149], v[148:149], v[34:35] op_sel_hi:[1,0]
    v_pk_mul_f32 v[150:151], v[150:151], v[34:35] op_sel_hi:[1,0]
    v_cvt_pk_bf16_f32 v156, v144, v145
    v_cvt_pk_bf16_f32 v157, v146, v147
    v_cvt_pk_bf16_f32 v158, v148, v149
    v_cvt_pk_bf16_f32 v159, v150, v151
    v_bfi_b32 v156, s54, v30, v156
    v_bfi_b32 v158, s54, v31, v158
    buffer_store_dwordx4 v[156:159], v0, s[40:43], s32 offen offset:1024
    s_barrier
    buffer_store_dwordx4 v[152:155], v0, s[40:43], s61 offen offset:0 sc1
    buffer_store_dwordx4 v[156:159], v0, s[40:43], s61 offen offset:1024 sc1
    s_waitcnt vmcnt(0)
    s_mov_b32 s3, 65536
.Lfp:
    buffer_load_dword v33, v17, s[40:43], s4 offen sc1
    s_sub_u32 s3, s3, 1
    s_cbranch_scc1 .Lfdone
.Lfp2:
    s_waitcnt vmcnt(0)
    v_cmp_ne_u32 vcc, s69, v33
    s_cbranch_vccnz .Lfp
.Lfdone:
    s_mov_b32 s3, 65536
    buffer_load_dwordx4 v[160:163], v0, s[40:43], s33 offen offset:0 sc1
    buffer_load_dwordx4 v[164:167], v0, s[40:43], s33 offen offset:1024 sc1
    buffer_load_dwordx4 v[176:179], v0, s[40:43], s34 offen offset:0 sc1
    buffer_load_dwordx4 v[180:183], v0, s[40:43], s34 offen offset:1024 sc1
    buffer_load_dwordx4 v[168:171], v0, s[40:43], s33 offen offset:2048 sc1
    buffer_load_dwordx4 v[172:175], v0, s[40:43], s33 offen offset:3072 sc1
    buffer_load_dwordx4 v[184:187], v0, s[40:43], s34 offen offset:2048 sc1
    buffer_load_dwordx4 v[188:191], v0, s[40:43], s34 offen offset:3072 sc1
    buffer_load_dwordx4 v[192:195], v0, s[40:43], s35 offen offset:0 sc1
    buffer_load_dwordx4 v[196:199], v0, s[40:43], s35 offen offset:1024 sc1
.Lrp:
    s_waitcnt vmcnt(9)
    v_xor_b32 v216, v160, v30
    v_bitop3_b32 v216, v216, v162, v31 bitop3:0xf6
    v_and_b32 v216, s54, v216
    v_mfma_f32_16x16x32_bf16 v[200:203], a[128:131], v[160:163], 0
    s_waitcnt vmcnt(8)
    v_xor_b32 v217, v164, v30
    v_bitop3_b32 v217, v217, v166, v31 bitop3:0xf6
    v_and_b32 v217, s54, v217
    v_or_b32 v33, v216, v217
    v_mfma_f32_16x16x32_bf16 v[200:203], a[128:131], v[164:167], v[200:203]
    s_waitcnt vmcnt(7)
    v_xor_b32 v220, v176, v30
    v_bitop3_b32 v220, v220, v178, v31 bitop3:0xf6
    v_and_b32 v220, s54, v220
    v_or_b32 v33, v33, v220
    v_mfma_f32_16x16x32_bf16 v[204:207], a[128:131], v[176:179], 0
    s_waitcnt vmcnt(6)
    v_xor_b32 v221, v180, v30
    v_bitop3_b32 v221, v221, v182, v31 bitop3:0xf6
    v_and_b32 v221, s54, v221
    v_or_b32 v33, v33, v221
    v_mfma_f32_16x16x32_bf16 v[204:207], a[128:131], v[180:183], v[204:207]
    s_waitcnt vmcnt(5)
    v_xor_b32 v218, v168, v30
    v_bitop3_b32 v218, v218, v170, v31 bitop3:0xf6
    v_and_b32 v218, s54, v218
    v_or_b32 v33, v33, v218
    v_mfma_f32_16x16x32_bf16 v[200:203], a[132:135], v[168:171], v[200:203]
    s_waitcnt vmcnt(4)
    v_xor_b32 v219, v172, v30
    v_bitop3_b32 v219, v219, v174, v31 bitop3:0xf6
    v_and_b32 v219, s54, v219
    v_or_b32 v33, v33, v219
    v_mfma_f32_16x16x32_bf16 v[200:203], a[132:135], v[172:175], v[200:203]
    s_waitcnt vmcnt(3)
    v_xor_b32 v222, v184, v30
    v_bitop3_b32 v222, v222, v186, v31 bitop3:0xf6
    v_and_b32 v222, s54, v222
    v_or_b32 v33, v33, v222
    v_mfma_f32_16x16x32_bf16 v[204:207], a[132:135], v[184:187], v[204:207]
    s_waitcnt vmcnt(2)
    v_xor_b32 v223, v188, v30
    v_bitop3_b32 v223, v223, v190, v31 bitop3:0xf6
    v_and_b32 v223, s54, v223
    v_or_b32 v33, v33, v223
    v_mfma_f32_16x16x32_bf16 v[204:207], a[132:135], v[188:191], v[204:207]
    s_waitcnt vmcnt(1)
    v_xor_b32 v224, v192, v30
    v_bitop3_b32 v224, v224, v194, v31 bitop3:0xf6
    v_and_b32 v224, s54, v224
    v_or_b32 v33, v33, v224
    v_mfma_f32_16x16x32_bf16 v[208:211], a[128:131], v[192:195], 0
    s_waitcnt vmcnt(0)
    v_xor_b32 v225, v196, v30
    v_bitop3_b32 v225, v225, v198, v31 bitop3:0xf6
    v_and_b32 v225, s54, v225
    v_or_b32 v33, v33, v225
    v_mfma_f32_16x16x32_bf16 v[208:211], a[128:131], v[196:199], v[208:211]
    v_cmp_ne_u32 vcc, 0, v33
    s_cbranch_vccnz .Lrretry
.Lrback:
    v_cvt_pk_bf16_f32 v200, v200, v201
    v_cvt_pk_bf16_f32 v201, v202, v203
    buffer_store_dwordx2 v[200:201], v32, s[44:47], s36 offen
    v_cvt_pk_bf16_f32 v204, v204, v205
    v_cvt_pk_bf16_f32 v205, v206, v207
    buffer_store_dwordx2 v[204:205], v32, s[44:47], s37 offen
    v_cvt_pk_bf16_f32 v208, v208, v209
    v_cvt_pk_bf16_f32 v209, v210, v211
    s_mov_b32 exec_hi, 0
    buffer_store_dwordx2 v[208:209], v19, s[44:47], s38 offen
    s_and_b32 s61, s2, 31
    s_or_b32 s61, s61, s48
    s_cmp_lg_u32 s61, 0
    s_cbranch_scc1 .Lnoep
    v_lshlrev_b32 v34, 9, v1
    s_lshl_b32 s61, s66, 14
    s_add_u32 s61, s61, 7344128
.Lep:
    buffer_load_dword v33, v34, s[40:43], s61 offen sc1
    s_sub_u32 s3, s3, 1
    s_cbranch_scc1 .Lep2
    s_waitcnt vmcnt(0)
    v_cmp_ne_u32 vcc, s69, v33
    s_cbranch_vccnz .Lep
.Lep2:
    s_lshl_b32 s61, s66, 7
    v_mov_b32 v35, s69
    s_mov_b64 exec, 1
    buffer_store_dword v35, off, s[40:43], s61 sc1
.Lnoep:
    s_endpgm
.Lrretry:
    s_sub_u32 s3, s3, 1
    s_cbranch_scc1 .Lrback
    s_nop 7
    v_or_b32_dpp v216, v216, v216 row_half_mirror row_mask:0xf bank_mask:0xf
    v_or_b32_dpp v217, v217, v217 row_half_mirror row_mask:0xf bank_mask:0xf
    v_or_b32_dpp v218, v218, v218 row_half_mirror row_mask:0xf bank_mask:0xf
    v_or_b32_dpp v219, v219, v219 row_half_mirror row_mask:0xf bank_mask:0xf
    v_or_b32_dpp v220, v220, v220 row_half_mirror row_mask:0xf bank_mask:0xf
    v_or_b32_dpp v221, v221, v221 row_half_mirror row_mask:0xf bank_mask:0xf
    v_or_b32_dpp v222, v222, v222 row_half_mirror row_mask:0xf bank_mask:0xf
    v_or_b32_dpp v223, v223, v223 row_half_mirror row_mask:0xf bank_mask:0xf
    v_or_b32_dpp v224, v224, v224 row_half_mirror row_mask:0xf bank_mask:0xf
    v_or_b32_dpp v225, v225, v225 row_half_mirror row_mask:0xf bank_mask:0xf
    v_cmp_ne_u32 s[4:5], 0, v216
    v_cmp_ne_u32 s[6:7], 0, v217
    v_cmp_ne_u32 s[8:9], 0, v218
    v_cmp_ne_u32 s[10:11], 0, v219
    v_cmp_ne_u32 s[12:13], 0, v220
    v_cmp_ne_u32 s[20:21], 0, v221
    v_cmp_ne_u32 s[22:23], 0, v222
    v_cmp_ne_u32 s[24:25], 0, v223
    v_cmp_ne_u32 s[26:27], 0, v224
    v_cmp_ne_u32 s[28:29], 0, v225
    s_wqm_b64 exec, s[4:5]
    buffer_load_dwordx4 v[160:163], v0, s[40:43], s33 offen offset:0 sc1
    s_wqm_b64 exec, s[6:7]
    buffer_load_dwordx4 v[164:167], v0, s[40:43], s33 offen offset:1024 sc1
    s_wqm_b64 exec, s[12:13]
    buffer_load_dwordx4 v[176:179], v0, s[40:43], s34 offen offset:0 sc1
    s_wqm_b64 exec, s[20:21]
    buffer_load_dwordx4 v[180:183], v0, s[40:43], s34 offen offset:1024 sc1
    s_wqm_b64 exec, s[8:9]
    buffer_load_dwordx4 v[168:171], v0, s[40:43], s33 offen offset:2048 sc1
    s_wqm_b64 exec, s[10:11]
    buffer_load_dwordx4 v[172:175], v0, s[40:43], s33 offen offset:3072 sc1
    s_wqm_b64 exec, s[22:23]
    buffer_load_dwordx4 v[184:187], v0, s[40:43], s34 offen offset:2048 sc1
    s_wqm_b64 exec, s[24:25]
    buffer_load_dwordx4 v[188:191], v0, s[40:43], s34 offen offset:3072 sc1
    s_wqm_b64 exec, s[26:27]
    buffer_load_dwordx4 v[192:195], v0, s[40:43], s35 offen offset:0 sc1
    s_wqm_b64 exec, s[28:29]
    buffer_load_dwordx4 v[196:199], v0, s[40:43], s35 offen offset:1024 sc1
    s_mov_b64 exec, -1
    s_branch .Lrp
.p2align 12
.LmB:
    s_waitcnt vmcnt(9)
    s_barrier
    ds_read_b64_tr_b16 a[0:1], v21 offset:4096
    ds_read_b64_tr_b16 a[2:3], v21 offset:4608
    ds_read_b128 a[48:51], v17 offset:0
    ds_read_b128 a[52:55], v18 offset:0
    ds_read_b128 a[56:59], v19 offset:0
    ds_read_b128 a[60:63], v20 offset:0
    ds_read_b64_tr_b16 a[4:5], v22 offset:4096
    ds_read_b64_tr_b16 a[6:7], v22 offset:4608
    ds_read_b64_tr_b16 a[8:9], v23 offset:4096
    ds_read_b64_tr_b16 a[10:11], v23 offset:4608
    ds_read_b64_tr_b16 a[12:13], v24 offset:4096
    ds_read_b64_tr_b16 a[14:15], v24 offset:4608
    ds_read_b64_tr_b16 a[16:17], v21 offset:5120
    ds_read_b64_tr_b16 a[18:19], v21 offset:5632
    ds_read_b64_tr_b16 a[20:21], v22 offset:5120
    ds_read_b64_tr_b16 a[22:23], v22 offset:5632
    s_waitcnt lgkmcnt(8)
    v_mfma_f32_32x32x16_bf16 v[40:55], a[48:51], a[0:3], 0
    ds_read_b64_tr_b16 a[24:25], v23 offset:5120
    ds_read_b64_tr_b16 a[26:27], v23 offset:5632
    s_add_u32 m0, s49, 16384
    s_add_u32 s62, s32, s57
    buffer_load_dwordx4 v2, s[20:23], s62 offen offset:0 lds
    v_mfma_f32_32x32x16_bf16 v[56:71], a[48:51], a[4:7], 0
    ds_read_b64_tr_b16 a[28:29], v24 offset:5120
    ds_read_b64_tr_b16 a[30:31], v24 offset:5632
    buffer_load_dwordx4 v3, s[20:23], s62 offen offset:1024 lds
    s_waitcnt lgkmcnt(8)
    v_mfma_f32_32x32x16_bf16 v[40:55], a[52:55], a[8:11], v[40:55]
    ds_read_b64_tr_b16 a[32:33], v21 offset:6144
    ds_read_b64_tr_b16 a[34:35], v21 offset:6656
    buffer_load_dwordx4 v4, s[20:23], s62 offen offset:2048 lds
    v_mfma_f32_32x32x16_bf16 v[56:71], a[52:55], a[12:15], v[56:71]
    ds_read_b64_tr_b16 a[36:37], v22 offset:6144
    ds_read_b64_tr_b16 a[38:39], v22 offset:6656
    buffer_load_dwordx4 v5, s[20:23], s62 offen offset:3072 lds
    s_waitcnt lgkmcnt(8)
    v_mfma_f32_32x32x16_bf16 v[72:87], a[48:51], a[16:19], 0
    ds_read_b64_tr_b16 a[0:1], v23 offset:6144
    ds_read_b64_tr_b16 a[2:3], v23 offset:6656
    s_add_u32 m0, s49, 20480
    s_add_u32 s62, s36, s60
    buffer_load_dwordx4 v6, s[24:27], s62 offen offset:0 lds
    buffer_load_dwordx4 v7, s[24:27], s62 offen offset:1024 lds
    v_mfma_f32_32x32x16_bf16 v[88:103], a[48:51], a[20:23], 0
    ds_read_b64_tr_b16 a[4:5], v24 offset:6144
    ds_read_b64_tr_b16 a[6:7], v24 offset:6656
    buffer_load_dwordx4 v8, s[24:27], s62 offen offset:2048 lds
    s_waitcnt lgkmcnt(8)
    v_mfma_f32_32x32x16_bf16 v[72:87], a[52:55], a[24:27], v[72:87]
    ds_read_b64_tr_b16 a[8:9], v21 offset:7168
    ds_read_b64_tr_b16 a[10:11], v21 offset:7680
    buffer_load_dwordx4 v9, s[24:27], s62 offen offset:3072 lds
    v_mfma_f32_32x32x16_bf16 v[88:103], a[52:55], a[28:31], v[88:103]
    ds_read_b64_tr_b16 a[12:13], v22 offset:7168
    ds_read_b64_tr_b16 a[14:15], v22 offset:7680
    s_add_u32 m0, s49, 24576
    s_nop 0
    buffer_load_dwordx4 v10, s[24:27], s36 offen offset:0 lds
    buffer_load_dwordx4 v11, s[24:27], s36 offen offset:1024 lds
    s_waitcnt lgkmcnt(8)
    v_mfma_f32_32x32x16_bf16 v[40:55], a[56:59], a[32:35], v[40:55]
    ds_read_b64_tr_b16 a[16:17], v23 offset:7168
    ds_read_b64_tr_b16 a[18:19], v23 offset:7680
    buffer_load_dwordx4 v12, s[24:27], s36 offen offset:2048 lds
    v_mfma_f32_32x32x16_bf16 v[56:71], a[56:59], a[36:39], v[56:71]
    ds_read_b64_tr_b16 a[20:21], v24 offset:7168
    ds_read_b64_tr_b16 a[22:23], v24 offset:7680
    s_waitcnt vmcnt(16)
    ds_read_b128 a[64:67], v17 offset:8192
    s_add_u32 m0, s49, 27648
    s_add_u32 s62, s33, s55
    buffer_load_dwordx4 v2, s[20:23], s62 offen offset:0 lds
    s_waitcnt lgkmcnt(9)
    v_mfma_f32_32x32x16_bf16 v[40:55], a[60:63], a[0:3], v[40:55]
    s_waitcnt vmcnt(13)
    s_barrier
    ds_read_b64_tr_b16 a[24:25], v21 offset:12288
    ds_read_b64_tr_b16 a[26:27], v21 offset:12800
    ds_read_b128 a[68:71], v18 offset:8192
    ds_read_b128 a[72:75], v19 offset:8192
    v_mfma_f32_32x32x16_bf16 v[56:71], a[60:63], a[4:7], v[56:71]
    ds_read_b64_tr_b16 a[28:29], v22 offset:12288
    ds_read_b64_tr_b16 a[30:31], v22 offset:12800
    buffer_load_dwordx4 v3, s[20:23], s62 offen offset:1024 lds
    ds_read_b128 a[76:79], v20 offset:8192
    s_waitcnt lgkmcnt(12)
    v_mfma_f32_32x32x16_bf16 v[72:87], a[56:59], a[8:11], v[72:87]
    ds_read_b64_tr_b16 a[32:33], v23 offset:12288
    ds_read_b64_tr_b16 a[34:35], v23 offset:12800
    buffer_load_dwordx4 v4, s[20:23], s62 offen offset:2048 lds
    v_mfma_f32_32x32x16_bf16 v[88:103], a[56:59], a[12:15], v[88:103]
    ds_read_b64_tr_b16 a[36:37], v24 offset:12288
    ds_read_b64_tr_b16 a[38:39], v24 offset:12800
    s_waitcnt lgkmcnt(12)
    v_mfma_f32_32x32x16_bf16 v[72:87], a[60:63], a[16:19], v[72:87]
    ds_read_b64_tr_b16 a[0:1], v21 offset:13312
    ds_read_b64_tr_b16 a[2:3], v21 offset:13824
    buffer_load_dwordx4 v5, s[20:23], s62 offen offset:3072 lds
    v_mfma_f32_32x32x16_bf16 v[88:103], a[60:63], a[20:23], v[88:103]
    ds_read_b64_tr_b16 a[4:5], v22 offset:13312
    ds_read_b64_tr_b16 a[6:7], v22 offset:13824
    s_add_u32 m0, s49, 31744
    s_add_u32 s62, s37, s58
    buffer_load_dwordx4 v6, s[24:27], s62 offen offset:0 lds
    s_waitcnt lgkmcnt(9)
    v_mfma_f32_32x32x16_bf16 v[40:55], a[64:67], a[24:27], v[40:55]
    ds_read_b64_tr_b16 a[8:9], v23 offset:13312
    ds_read_b64_tr_b16 a[10:11], v23 offset:13824
    v_mfma_f32_32x32x16_bf16 v[56:71], a[64:67], a[28:31], v[56:71]
    ds_read_b64_tr_b16 a[12:13], v24 offset:13312
    ds_read_b64_tr_b16 a[14:15], v24 offset:13824
    buffer_load_dwordx4 v7, s[24:27], s62 offen offset:1024 lds
    s_waitcnt lgkmcnt(8)
    v_mfma_f32_32x32x16_bf16 v[40:55], a[68:71], a[32:35], v[40:55]
    ds_read_b64_tr_b16 a[16:17], v21 offset:14336
    ds_read_b64_tr_b16 a[18:19], v21 offset:14848
    buffer_load_dwordx4 v8, s[24:27], s62 offen offset:2048 lds
    v_mfma_f32_32x32x16_bf16 v[56:71], a[68:71], a[36:39], v[56:71]
    ds_read_b64_tr_b16 a[20:21], v22 offset:14336
    ds_read_b64_tr_b16 a[22:23], v22 offset:14848
    s_waitcnt lgkmcnt(8)
    v_mfma_f32_32x32x16_bf16 v[72:87], a[64:67], a[0:3], v[72:87]
    ds_read_b64_tr_b16 a[24:25], v23 offset:14336
    ds_read_b64_tr_b16 a[26:27], v23 offset:14848
    buffer_load_dwordx4 v9, s[24:27], s62 offen offset:3072 lds
    v_mfma_f32_32x32x16_bf16 v[88:103], a[64:67], a[4:7], v[88:103]
    ds_read_b64_tr_b16 a[28:29], v24 offset:14336
    ds_read_b64_tr_b16 a[30:31], v24 offset:14848
    s_add_u32 m0, s49, 35840
    s_add_u32 s62, s33, s56
    buffer_load_dwordx4 v2, s[20:23], s62 offen offset:0 nt lds
    s_waitcnt lgkmcnt(8)
    v_mfma_f32_32x32x16_bf16 v[72:87], a[68:71], a[8:11], v[72:87]
    ds_read_b64_tr_b16 a[32:33], v21 offset:15360
    ds_read_b64_tr_b16 a[34:35], v21 offset:15872
    buffer_load_dwordx4 v3, s[20:23], s62 offen offset:1024 nt lds
    v_mfma_f32_32x32x16_bf16 v[88:103], a[68:71], a[12:15], v[88:103]
    ds_read_b64_tr_b16 a[36:37], v22 offset:15360
    ds_read_b64_tr_b16 a[38:39], v22 offset:15872
    s_waitcnt lgkmcnt(8)
    v_mfma_f32_32x32x16_bf16 v[40:55], a[72:75], a[16:19], v[40:55]
    ds_read_b64_tr_b16 a[0:1], v23 offset:15360
    ds_read_b64_tr_b16 a[2:3], v23 offset:15872
    buffer_load_dwordx4 v4, s[20:23], s62 offen offset:2048 nt lds
    v_mfma_f32_32x32x16_bf16 v[56:71], a[72:75], a[20:23], v[56:71]
    ds_read_b64_tr_b16 a[4:5], v24 offset:15360
    ds_read_b64_tr_b16 a[6:7], v24 offset:15872
    s_waitcnt vmcnt(18)
    ds_read_b128 a[80:83], v17 offset:16384
    buffer_load_dwordx4 v5, s[20:23], s62 offen offset:3072 nt lds
    s_waitcnt lgkmcnt(9)
    v_mfma_f32_32x32x16_bf16 v[40:55], a[76:79], a[24:27], v[40:55]
    s_waitcnt vmcnt(15)
    s_barrier
    ds_read_b64_tr_b16 a[8:9], v21 offset:20480
    ds_read_b64_tr_b16 a[10:11], v21 offset:20992
    ds_read_b128 a[84:87], v18 offset:16384
    ds_read_b128 a[88:91], v19 offset:16384
    v_mfma_f32_32x32x16_bf16 v[56:71], a[76:79], a[28:31], v[56:71]
    ds_read_b64_tr_b16 a[12:13], v22 offset:20480
    ds_read_b64_tr_b16 a[14:15], v22 offset:20992
    s_add_u32 m0, s49, 0
    s_add_u32 s62, s37, s59
    buffer_load_dwordx4 v6, s[24:27], s62 offen offset:0 nt lds
    s_waitcnt lgkmcnt(11)
    v_mfma_f32_32x32x16_bf16 v[72:87], a[72:75], a[32:35], v[72:87]
    ds_read_b64_tr_b16 a[16:17], v23 offset:20480
    ds_read_b64_tr_b16 a[18:19], v23 offset:20992
    ds_read_b128 a[92:95], v20 offset:16384
    buffer_load_dwordx4 v7, s[24:27], s62 offen offset:1024 nt lds
    v_readfirstlane_b32 s69, v30
    v_mfma_f32_32x32x16_bf16 v[88:103], a[72:75], a[36:39], v[88:103]
    ds_read_b64_tr_b16 a[20:21], v24 offset:20480
    ds_read_b64_tr_b16 a[22:23], v24 offset:20992
    s_add_u32 s69, s69, 2654435761
    v_lshrrev_b32 v30, v31, s69
    v_lshrrev_b32 v31, 1, v30
    s_lshl_b32 s4, s66, 5
    s_waitcnt lgkmcnt(12)
    v_mfma_f32_32x32x16_bf16 v[72:87], a[76:79], a[0:3], v[72:87]
    ds_read_b64_tr_b16 a[24:25], v21 offset:22528
    ds_read_b64_tr_b16 a[26:27], v21 offset:23040
    buffer_load_dwordx4 v8, s[24:27], s62 offen offset:2048 nt lds
    s_add_u32 s5, s4, s64
    s_mul_i32 s5, s5, 57344
    v_mfma_f32_32x32x16_bf16 v[88:103], a[76:79], a[4:7], v[88:103]
    ds_read_b64_tr_b16 a[28:29], v22 offset:22528
    ds_read_b64_tr_b16 a[30:31], v22 offset:23040
    buffer_load_dwordx4 v9, s[24:27], s62 offen offset:3072 nt lds
    s_lshl_b32 s6, s48, 11
    s_add_u32 s5, s5, s6
    s_waitcnt lgkmcnt(9)
    v_mfma_f32_32x32x16_bf16 v[40:55], a[80:83], a[8:11], v[40:55]
    ds_read_b64_tr_b16 a[32:33], v23 offset:22528
    ds_read_b64_tr_b16 a[34:35], v23 offset:23040
    s_add_u32 s5, s5, 4096
    s_xor_b32 s6, s50, 0
    s_mul_i32 s6, s6, 458752
    s_add_u32 s44, s5, s6
    v_mfma_f32_32x32x16_bf16 v[56:71], a[80:83], a[12:15], v[56:71]
    ds_read_b64_tr_b16 a[36:37], v24 offset:22528
    ds_read_b64_tr_b16 a[38:39], v24 offset:23040
    s_add_u32 m0, s49, 4096
    s_add_u32 s62, s33, s57
    buffer_load_dwordx4 v2, s[20:23], s62 offen offset:0 nt lds
    s_waitcnt lgkmcnt(8)
    v_mfma_f32_32x32x16_bf16 v[40:55], a[84:87], a[16:19], v[40:55]
    ds_read_b64_tr_b16 a[0:1], v21 offset:21504
    ds_read_b64_tr_b16 a[2:3], v21 offset:22016
    buffer_load_dwordx4 v3, s[20:23], s62 offen offset:1024 nt lds
    s_xor_b32 s6, s50, 1
    s_mul_i32 s6, s6, 458752
    v_mfma_f32_32x32x16_bf16 v[56:71], a[84:87], a[20:23], v[56:71]
    ds_read_b64_tr_b16 a[4:5], v22 offset:21504
    ds_read_b64_tr_b16 a[6:7], v22 offset:22016
    buffer_load_dwordx4 v4, s[20:23], s62 offen offset:2048 nt lds
    s_add_u32 s45, s5, s6
    s_xor_b32 s6, s50, 2
    s_waitcnt lgkmcnt(8)
    v_mfma_f32_32x32x16_bf16 v[40:55], a[88:91], a[24:27], v[40:55]
    ds_read_b64_tr_b16 a[8:9], v23 offset:21504
    ds_read_b64_tr_b16 a[10:11], v23 offset:22016
    s_mul_i32 s6, s6, 458752
    s_add_u32 s46, s5, s6
    s_xor_b32 s6, s50, 3
    s_mul_i32 s6, s6, 458752
    v_mfma_f32_32x32x16_bf16 v[56:71], a[88:91], a[28:31], v[56:71]
    ds_read_b64_tr_b16 a[12:13], v24 offset:21504
    ds_read_b64_tr_b16 a[14:15], v24 offset:22016
    buffer_load_dwordx4 v5, s[20:23], s62 offen offset:3072 nt lds
    s_add_u32 s47, s5, s6
    s_lshl_b32 s5, s65, 3
    s_waitcnt lgkmcnt(8)
    v_mfma_f32_32x32x16_bf16 v[40:55], a[92:95], a[32:35], v[40:55]
    ds_read_b64_tr_b16 a[16:17], v21 offset:23552
    ds_read_b64_tr_b16 a[18:19], v21 offset:24064
    s_add_u32 m0, s49, 8192
    s_add_u32 s62, s37, s60
    buffer_load_dwordx4 v6, s[24:27], s62 offen offset:0 nt lds
    v_mfma_f32_32x32x16_bf16 v[56:71], a[92:95], a[36:39], v[56:71]
    ds_read_b64_tr_b16 a[20:21], v22 offset:23552
    ds_read_b64_tr_b16 a[22:23], v22 offset:24064
    s_add_u32 s4, s4, s5
    s_lshl_b32 s5, s48, 1
    s_add_u32 s4, s4, s5
    s_mul_i32 s4, s4, 57344
    s_waitcnt lgkmcnt(8)
    v_mfma_f32_32x32x16_bf16 v[72:87], a[80:83], a[0:3], v[72:87]
    ds_read_b64_tr_b16 a[24:25], v23 offset:23552
    ds_read_b64_tr_b16 a[26:27], v23 offset:24064
    buffer_load_dwordx4 v7, s[24:27], s62 offen offset:1024 nt lds
    v_cvt_pk_bf16_f32 v192, v40, v41
    v_cvt_pk_bf16_f32 v193, v42, v43
    v_mfma_f32_32x32x16_bf16 v[88:103], a[80:83], a[4:7], v[88:103]
    ds_read_b64_tr_b16 a[28:29], v24 offset:23552
    ds_read_b64_tr_b16 a[30:31], v24 offset:24064
    buffer_load_dwordx4 v8, s[24:27], s62 offen offset:2048 nt lds
    v_cvt_pk_bf16_f32 v194, v44, v45
    v_cvt_pk_bf16_f32 v195, v46, v47
    s_waitcnt lgkmcnt(8)
    v_mfma_f32_32x32x16_bf16 v[72:87], a[84:87], a[8:11], v[72:87]
    s_waitcnt vmcnt(23)
    s_barrier
    ds_read_b64_tr_b16 a[32:33], v25 offset:24576
    ds_read_b64_tr_b16 a[34:35], v25 offset:24832
    v_cvt_pk_bf16_f32 v196, v48, v49
    v_cvt_pk_bf16_f32 v197, v50, v51
    v_mfma_f32_32x32x16_bf16 v[88:103], a[84:87], a[12:15], v[88:103]
    ds_read_b64_tr_b16 a[36:37], v26 offset:24576
    ds_read_b64_tr_b16 a[38:39], v26 offset:24832
    buffer_load_dwordx4 v9, s[24:27], s62 offen offset:3072 nt lds
    v_cvt_pk_bf16_f32 v198, v52, v53
    v_cvt_pk_bf16_f32 v199, v54, v55
    s_waitcnt lgkmcnt(8)
    v_mfma_f32_32x32x16_bf16 v[72:87], a[88:91], a[16:19], v[72:87]
    ds_read_b64_tr_b16 a[0:1], v27 offset:24576
    ds_read_b64_tr_b16 a[2:3], v27 offset:24832
    s_add_u32 m0, s49, 12288
    s_nop 0
    buffer_load_dwordx4 v10, s[24:27], s37 offen offset:0 nt lds
    v_accvgpr_write_b32 a144, v192
    v_mfma_f32_32x32x16_bf16 v[88:103], a[88:91], a[20:23], v[88:103]
    ds_read_b64_tr_b16 a[4:5], v28 offset:24576
    ds_read_b64_tr_b16 a[6:7], v28 offset:24832
    v_accvgpr_write_b32 a145, v193
    v_accvgpr_write_b32 a146, v194
    v_accvgpr_write_b32 a147, v195
    v_accvgpr_write_b32 a148, v196
    s_waitcnt lgkmcnt(8)
    v_mfma_f32_32x32x16_bf16 v[72:87], a[92:95], a[24:27], v[72:87]
    ds_read_b64_tr_b16 a[8:9], v25 offset:25600
    ds_read_b64_tr_b16 a[10:11], v25 offset:25856
    buffer_load_dwordx4 v11, s[24:27], s37 offen offset:1024 nt lds
    v_accvgpr_write_b32 a149, v197
    v_accvgpr_write_b32 a150, v198
    v_mfma_f32_32x32x16_bf16 v[88:103], a[92:95], a[28:31], v[88:103]
    ds_read_b64_tr_b16 a[12:13], v26 offset:25600
    ds_read_b64_tr_b16 a[14:15], v26 offset:25856
    buffer_load_dwordx4 v12, s[24:27], s37 offen offset:2048 nt lds
    v_accvgpr_write_b32 a151, v199
    v_cvt_pk_bf16_f32 v200, v56, v57
    s_waitcnt lgkmcnt(8)
    v_mfma_f32_32x32x16_bf16 v[104:119], a[48:51], a[32:35], 0
    ds_read_b64_tr_b16 a[16:17], v27 offset:25600
    ds_read_b64_tr_b16 a[18:19], v27 offset:25856
    s_add_u32 m0, s49, 15360
    s_add_u32 s62, s34, s55
    buffer_load_dwordx4 v2, s[20:23], s62 offen offset:0 lds
    v_mfma_f32_32x32x16_bf16 v[104:119], a[52:55], a[36:39], v[104:119]
    ds_read_b64_tr_b16 a[20:21], v28 offset:25600
    ds_read_b64_tr_b16 a[22:23], v28 offset:25856
    v_cvt_pk_bf16_f32 v201, v58, v59
    v_cvt_pk_bf16_f32 v202, v60, v61
    v_cvt_pk_bf16_f32 v203, v62, v63
    v_cvt_pk_bf16_f32 v204, v64, v65
    s_waitcnt lgkmcnt(8)
    v_mfma_f32_32x32x16_bf16 v[104:119], a[56:59], a[0:3], v[104:119]
    ds_read_b64_tr_b16 a[24:25], v25 offset:26624
    ds_read_b64_tr_b16 a[26:27], v25 offset:26880
    buffer_load_dwordx4 v3, s[20:23], s62 offen offset:1024 lds
    v_cvt_pk_bf16_f32 v205, v66, v67
    v_cvt_pk_bf16_f32 v206, v68, v69
    v_mfma_f32_32x32x16_bf16 v[104:119], a[60:63], a[4:7], v[104:119]
    ds_read_b64_tr_b16 a[28:29], v26 offset:26624
    ds_read_b64_tr_b16 a[30:31], v26 offset:26880
    buffer_load_dwordx4 v4, s[20:23], s62 offen offset:2048 lds
    v_cvt_pk_bf16_f32 v207, v70, v71
    v_accvgpr_write_b32 a152, v200
    s_waitcnt lgkmcnt(8)
    v_mfma_f32_32x32x16_bf16 v[104:119], a[64:67], a[8:11], v[104:119]
    ds_read_b64_tr_b16 a[32:33], v27 offset:26624
    ds_read_b64_tr_b16 a[34:35], v27 offset:26880
    v_accvgpr_write_b32 a153, v201
    v_accvgpr_write_b32 a154, v202
    v_accvgpr_write_b32 a155, v203
    v_accvgpr_write_b32 a156, v204
    v_mfma_f32_32x32x16_bf16 v[104:119], a[68:71], a[12:15], v[104:119]
    ds_read_b64_tr_b16 a[36:37], v28 offset:26624
    ds_read_b64_tr_b16 a[38:39], v28 offset:26880
    s_waitcnt vmcnt(26)
    ds_read_b128 a[96:99], v17 offset:27648
    buffer_load_dwordx4 v5, s[20:23], s62 offen offset:3072 lds
    s_waitcnt lgkmcnt(9)
    v_mfma_f32_32x32x16_bf16 v[104:119], a[72:75], a[16:19], v[104:119]
    s_waitcnt vmcnt(23)
    s_barrier
    ds_read_b64_tr_b16 a[0:1], v21 offset:31744
    ds_read_b64_tr_b16 a[2:3], v21 offset:32256
    ds_read_b128 a[100:103], v18 offset:27648
    s_add_u32 m0, s49, 19456
    s_add_u32 s62, s38, s58
    buffer_load_dwordx4 v6, s[24:27], s62 offen offset:0 lds
    v_mfma_f32_32x32x16_bf16 v[104:119], a[76:79], a[20:23], v[104:119]
    ds_read_b64_tr_b16 a[4:5], v22 offset:31744
    ds_read_b64_tr_b16 a[6:7], v22 offset:32256
    ds_read_b128 a[104:107], v19 offset:27648
    ds_read_b128 a[108:111], v20 offset:27648
    v_accvgpr_write_b32 a157, v205
    v_accvgpr_write_b32 a158, v206
    s_waitcnt lgkmcnt(12)
    v_mfma_f32_32x32x16_bf16 v[104:119], a[80:83], a[24:27], v[104:119]
    ds_read_b64_tr_b16 a[8:9], v23 offset:31744
    ds_read_b64_tr_b16 a[10:11], v23 offset:32256
    buffer_load_dwordx4 v7, s[24:27], s62 offen offset:1024 lds
    v_accvgpr_write_b32 a159, v207
    v_cvt_pk_bf16_f32 v208, v72, v73
    v_mfma_f32_32x32x16_bf16 v[104:119], a[84:87], a[28:31], v[104:119]
    ds_read_b64_tr_b16 a[12:13], v24 offset:31744
    ds_read_b64_tr_b16 a[14:15], v24 offset:32256
    buffer_load_dwordx4 v8, s[24:27], s62 offen offset:2048 lds
    v_cvt_pk_bf16_f32 v209, v74, v75
    v_cvt_pk_bf16_f32 v210, v76, v77
    s_waitcnt lgkmcnt(12)
    v_mfma_f32_32x32x16_bf16 v[104:119], a[88:91], a[32:35], v[104:119]
    ds_read_b64_tr_b16 a[16:17], v21 offset:32768
    ds_read_b64_tr_b16 a[18:19], v21 offset:33280
    v_cvt_pk_bf16_f32 v211, v78, v79
    v_cvt_pk_bf16_f32 v212, v80, v81
    v_cvt_pk_bf16_f32 v213, v82, v83
    v_cvt_pk_bf16_f32 v214, v84, v85
    v_mfma_f32_32x32x16_bf16 v[104:119], a[92:95], a[36:39], v[104:119]
    ds_read_b64_tr_b16 a[20:21], v22 offset:32768
    ds_read_b64_tr_b16 a[22:23], v22 offset:33280
    buffer_load_dwordx4 v9, s[24:27], s62 offen offset:3072 lds
    v_cvt_pk_bf16_f32 v215, v86, v87
    v_accvgpr_write_b32 a160, v208
    s_waitcnt lgkmcnt(10)
    v_mfma_f32_32x32x16_bf16 v[40:55], a[96:99], a[0:3], 0
    ds_read_b64_tr_b16 a[24:25], v23 offset:32768
    ds_read_b64_tr_b16 a[26:27], v23 offset:33280
    v_accvgpr_write_b32 a161, v209
    v_accvgpr_write_b32 a162, v210
    v_accvgpr_write_b32 a163, v211
    v_accvgpr_write_b32 a164, v212
    v_mfma_f32_32x32x16_bf16 v[56:71], a[96:99], a[4:7], 0
    ds_read_b64_tr_b16 a[28:29], v24 offset:32768
    ds_read_b64_tr_b16 a[30:31], v24 offset:33280
    v_accvgpr_write_b32 a165, v213
    v_accvgpr_write_b32 a166, v214
    v_accvgpr_write_b32 a167, v215
    v_cvt_pk_bf16_f32 v216, v88, v89
    s_waitcnt lgkmcnt(8)
    v_mfma_f32_32x32x16_bf16 v[40:55], a[100:103], a[8:11], v[40:55]
    ds_read_b64_tr_b16 a[32:33], v21 offset:33792
    ds_read_b64_tr_b16 a[34:35], v21 offset:34304
    s_add_u32 m0, s49, 27648
    s_add_u32 s62, s34, s56
    buffer_load_dwordx4 v2, s[20:23], s62 offen offset:0 lds
    v_mfma_f32_32x32x16_bf16 v[56:71], a[100:103], a[12:15], v[56:71]
    ds_read_b64_tr_b16 a[36:37], v22 offset:33792
    ds_read_b64_tr_b16 a[38:39], v22 offset:34304
    buffer_load_dwordx4 v3, s[20:23], s62 offen offset:1024 lds
    v_cvt_pk_bf16_f32 v217, v90, v91
    v_cvt_pk_bf16_f32 v218, v92, v93
    s_waitcnt lgkmcnt(8)
    v_mfma_f32_32x32x16_bf16 v[72:87], a[96:99], a[16:19], 0
    ds_read_b64_tr_b16 a[0:1], v23 offset:33792
    ds_read_b64_tr_b16 a[2:3], v23 offset:34304
    buffer_load_dwordx4 v4, s[20:23], s62 offen offset:2048 lds
    v_cvt_pk_bf16_f32 v219, v94, v95
    v_cvt_pk_bf16_f32 v220, v96, v97
    v_cvt_pk_bf16_f32 v221, v98, v99
    v_cvt_pk_bf16_f32 v222, v100, v101
    v_cvt_pk_bf16_f32 v223, v102, v103
    v_mfma_f32_32x32x16_bf16 v[88:103], a[96:99], a[20:23], 0
    ds_read_b64_tr_b16 a[4:5], v24 offset:33792
    ds_read_b64_tr_b16 a[6:7], v24 offset:34304
    buffer_load_dwordx4 v5, s[20:23], s62 offen offset:3072 lds
    v_accvgpr_write_b32 a168, v216
    v_accvgpr_write_b32 a169, v217
    s_waitcnt lgkmcnt(8)
    v_mfma_f32_32x32x16_bf16 v[72:87], a[100:103], a[24:27], v[72:87]
    ds_read_b64_tr_b16 a[8:9], v21 offset:34816
    ds_read_b64_tr_b16 a[10:11], v21 offset:35328
    v_accvgpr_write_b32 a170, v218
    v_accvgpr_write_b32 a171, v219
    v_accvgpr_write_b32 a172, v220
    v_accvgpr_write_b32 a173, v221
    v_mfma_f32_32x32x16_bf16 v[88:103], a[100:103], a[28:31], v[88:103]
    ds_read_b64_tr_b16 a[12:13], v22 offset:34816
    ds_read_b64_tr_b16 a[14:15], v22 offset:35328
    v_accvgpr_write_b32 a174, v222
    v_accvgpr_write_b32 a175, v223
    v_cvt_pk_bf16_f32 v224, v104, v105
    v_cvt_pk_bf16_f32 v225, v106, v107
    s_waitcnt lgkmcnt(8)
    v_mfma_f32_32x32x16_bf16 v[40:55], a[104:107], a[32:35], v[40:55]
    ds_read_b64_tr_b16 a[16:17], v23 offset:34816
    ds_read_b64_tr_b16 a[18:19], v23 offset:35328
    v_cvt_pk_bf16_f32 v226, v108, v109
    v_cvt_pk_bf16_f32 v227, v110, v111
    v_cvt_pk_bf16_f32 v228, v112, v113
    v_cvt_pk_bf16_f32 v229, v114, v115
    v_mfma_f32_32x32x16_bf16 v[56:71], a[104:107], a[36:39], v[56:71]
    ds_read_b64_tr_b16 a[20:21], v24 offset:34816
    ds_read_b64_tr_b16 a[22:23], v24 offset:35328
    s_waitcnt vmcnt(27)
    ds_read_b128 a[112:115], v17 offset:35840
    ds_read_b128 a[116:119], v18 offset:35840
    v_cvt_pk_bf16_f32 v230, v116, v117
    s_waitcnt lgkmcnt(10)
    v_mfma_f32_32x32x16_bf16 v[40:55], a[108:111], a[0:3], v[40:55]
    s_waitcnt vmcnt(23)
    s_barrier
    ds_read_b64_tr_b16 a[24:25], v21 offset:0
    ds_read_b64_tr_b16 a[26:27], v21 offset:512
    ds_read_b128 a[120:123], v19 offset:35840
    v_cvt_pk_bf16_f32 v231, v118, v119
    v_mfma_f32_32x32x16_bf16 v[56:71], a[108:111], a[4:7], v[56:71]
    ds_read_b64_tr_b16 a[28:29], v22 offset:0
    ds_read_b64_tr_b16 a[30:31], v22 offset:512
    s_add_u32 m0, s49, 23552
    s_add_u32 s62, s38, s59
    buffer_load_dwordx4 v6, s[24:27], s62 offen offset:0 lds
    s_waitcnt lgkmcnt(11)
    v_mfma_f32_32x32x16_bf16 v[72:87], a[104:107], a[8:11], v[72:87]
    ds_read_b64_tr_b16 a[32:33], v23 offset:0
    ds_read_b64_tr_b16 a[34:35], v23 offset:512
    ds_read_b128 a[124:127], v20 offset:35840
    buffer_load_dwordx4 v7, s[24:27], s62 offen offset:1024 lds
    v_accvgpr_write_b32 a176, v224
    v_mfma_f32_32x32x16_bf16 v[88:103], a[104:107], a[12:15], v[88:103]
    ds_read_b64_tr_b16 a[36:37], v24 offset:0
    ds_read_b64_tr_b16 a[38:39], v24 offset:512
    v_accvgpr_write_b32 a177, v225
    v_accvgpr_write_b32 a178, v226
    v_accvgpr_write_b32 a179, v227
    v_accvgpr_write_b32 a180, v228
    s_waitcnt lgkmcnt(12)
    v_mfma_f32_32x32x16_bf16 v[72:87], a[108:111], a[16:19], v[72:87]
    ds_read_b64_tr_b16 a[0:1], v21 offset:1024
    ds_read_b64_tr_b16 a[2:3], v21 offset:1536
    buffer_load_dwordx4 v8, s[24:27], s62 offen offset:2048 lds
    v_accvgpr_write_b32 a181, v229
    v_accvgpr_write_b32 a182, v230
    v_mfma_f32_32x32x16_bf16 v[88:103], a[108:111], a[20:23], v[88:103]
    ds_read_b64_tr_b16 a[4:5], v22 offset:1024
    ds_read_b64_tr_b16 a[6:7], v22 offset:1536
    buffer_load_dwordx4 v9, s[24:27], s62 offen offset:3072 lds
    v_accvgpr_write_b32 a183, v231
    s_lshl_b32 s5, s64, 8
    s_waitcnt lgkmcnt(9)
    v_mfma_f32_32x32x16_bf16 v[40:55], a[112:115], a[24:27], v[40:55]
    ds_read_b64_tr_b16 a[8:9], v23 offset:1024
    ds_read_b64_tr_b16 a[10:11], v23 offset:1536
    s_add_u32 s4, s4, s5
    s_add_u32 s52, s4, 20480
    s_add_u32 s53, s4, 40960
    s_lshl_b32 s63, s2, 2
    v_mfma_f32_32x32x16_bf16 v[56:71], a[112:115], a[28:31], v[56:71]
    ds_read_b64_tr_b16 a[12:13], v24 offset:1024
    ds_read_b64_tr_b16 a[14:15], v24 offset:1536
    s_add_u32 s63, s63, s48
    s_lshl_b32 s63, s63, 7
    s_add_u32 s63, s63, 7278592
    v_bfe_u32 v33, v1, 4, 1
    s_waitcnt lgkmcnt(8)
    v_mfma_f32_32x32x16_bf16 v[40:55], a[116:119], a[32:35], v[40:55]
    ds_read_b64_tr_b16 a[16:17], v21 offset:2048
    ds_read_b64_tr_b16 a[18:19], v21 offset:2560
    s_add_u32 m0, s49, 35840
    s_add_u32 s62, s34, s57
    buffer_load_dwordx4 v2, s[20:23], s62 offen offset:0 lds
    v_mfma_f32_32x32x16_bf16 v[56:71], a[116:119], a[36:39], v[56:71]
    ds_read_b64_tr_b16 a[20:21], v22 offset:2048
    ds_read_b64_tr_b16 a[22:23], v22 offset:2560
    buffer_load_dwordx4 v3, s[20:23], s62 offen offset:1024 lds
    v_mul_u32_u24 v29, 57344, v33
    v_mul_u32_u24 v33, 10240, v38
    s_waitcnt lgkmcnt(8)
    v_mfma_f32_32x32x16_bf16 v[72:87], a[112:115], a[0:3], v[72:87]
    ds_read_b64_tr_b16 a[24:25], v23 offset:2048
    ds_read_b64_tr_b16 a[26:27], v23 offset:2560
    buffer_load_dwordx4 v4, s[20:23], s62 offen offset:2048 lds
    v_add_u32 v29, v29, v33
    v_and_b32 v33, 0x70, v0
    v_mfma_f32_32x32x16_bf16 v[88:103], a[112:115], a[4:7], v[88:103]
    ds_read_b64_tr_b16 a[28:29], v24 offset:2048
    ds_read_b64_tr_b16 a[30:31], v24 offset:2560
    buffer_load_dwordx4 v5, s[20:23], s62 offen offset:3072 lds
    v_add_u32 v29, v29, v33
    v_and_b32 v33, 8, v1
    s_waitcnt lgkmcnt(8)
    v_mfma_f32_32x32x16_bf16 v[72:87], a[116:119], a[8:11], v[72:87]
    ds_read_b64_tr_b16 a[32:33], v21 offset:3072
    ds_read_b64_tr_b16 a[34:35], v21 offset:3584
    v_lshl_add_u32 v1, v33, 4, v29
    v_lshl_add_u32 v29, v33, 9, v29
    v_add_u32 v1, 8192, v1
    v_mov_b32 v32, s69
    v_mfma_f32_32x32x16_bf16 v[88:103], a[116:119], a[12:15], v[88:103]
    ds_read_b64_tr_b16 a[36:37], v22 offset:3072
    ds_read_b64_tr_b16 a[38:39], v22 offset:3584
    s_waitcnt lgkmcnt(8)
    v_mfma_f32_32x32x16_bf16 v[40:55], a[120:123], a[16:19], v[40:55]
    ds_read_b64_tr_b16 a[0:1], v23 offset:3072
    ds_read_b64_tr_b16 a[2:3], v23 offset:3584
    v_mfma_f32_32x32x16_bf16 v[56:71], a[120:123], a[20:23], v[56:71]
    s_branch .LskB1
.p2align 12
.LstB1:
    s_branch .LmB
.LskB1:
    ds_read_b64_tr_b16 a[4:5], v24 offset:3072
    ds_read_b64_tr_b16 a[6:7], v24 offset:3584
    s_waitcnt vmcnt(27)
    ds_read_b128 a[128:131], v17 offset:4096
    ds_read_b128 a[132:135], v18 offset:4096
    s_waitcnt lgkmcnt(10)
    v_mfma_f32_32x32x16_bf16 v[40:55], a[124:127], a[24:27], v[40:55]
    s_waitcnt vmcnt(23)
    s_barrier
    ds_read_b64_tr_b16 a[8:9], v21 offset:8192
    ds_read_b64_tr_b16 a[10:11], v21 offset:8704
    ds_read_b128 a[136:139], v19 offset:4096
    v_mfma_f32_32x32x16_bf16 v[56:71], a[124:127], a[28:31], v[56:71]
    ds_read_b64_tr_b16 a[12:13], v22 offset:8192
    ds_read_b64_tr_b16 a[14:15], v22 offset:8704
    s_add_u32 m0, s49, 31744
    s_add_u32 s62, s38, s60
    buffer_load_dwordx4 v6, s[24:27], s62 offen offset:0 lds
    s_waitcnt lgkmcnt(11)
    v_mfma_f32_32x32x16_bf16 v[72:87], a[120:123], a[32:35], v[72:87]
    ds_read_b64_tr_b16 a[16:17], v23 offset:8192
    ds_read_b64_tr_b16 a[18:19], v23 offset:8704
    ds_read_b128 a[140:143], v20 offset:4096
    v_mfma_f32_32x32x16_bf16 v[88:103], a[120:123], a[36:39], v[88:103]
    ds_read_b64_tr_b16 a[20:21], v24 offset:8192
    ds_read_b64_tr_b16 a[22:23], v24 offset:8704
    buffer_load_dwordx4 v7, s[24:27], s62 offen offset:1024 lds
    s_waitcnt lgkmcnt(12)
    v_mfma_f32_32x32x16_bf16 v[72:87], a[124:127], a[0:3], v[72:87]
    ds_read_b64_tr_b16 a[24:25], v21 offset:10240
    ds_read_b64_tr_b16 a[26:27], v21 offset:10752
    v_mfma_f32_32x32x16_bf16 v[88:103], a[124:127], a[4:7], v[88:103]
    ds_read_b64_tr_b16 a[28:29], v22 offset:10240
    ds_read_b64_tr_b16 a[30:31], v22 offset:10752
    buffer_load_dwordx4 v8, s[24:27], s62 offen offset:2048 lds
    s_waitcnt lgkmcnt(9)
    v_mfma_f32_32x32x16_bf16 v[40:55], a[128:131], a[8:11], v[40:55]
    ds_read_b64_tr_b16 a[32:33], v23 offset:10240
    ds_read_b64_tr_b16 a[34:35], v23 offset:10752
    v_mfma_f32_32x32x16_bf16 v[56:71], a[128:131], a[12:15], v[56:71]
    ds_read_b64_tr_b16 a[36:37], v24 offset:10240
    ds_read_b64_tr_b16 a[38:39], v24 offset:10752
    buffer_load_dwordx4 v9, s[24:27], s62 offen offset:3072 lds
    s_waitcnt lgkmcnt(8)
    v_mfma_f32_32x32x16_bf16 v[40:55], a[132:135], a[16:19], v[40:55]
    ds_read_b64_tr_b16 a[0:1], v21 offset:9216
    ds_read_b64_tr_b16 a[2:3], v21 offset:9728
    v_mfma_f32_32x32x16_bf16 v[56:71], a[132:135], a[20:23], v[56:71]
    ds_read_b64_tr_b16 a[4:5], v22 offset:9216
    ds_read_b64_tr_b16 a[6:7], v22 offset:9728
    s_add_u32 m0, s49, 0
    s_nop 0
    buffer_load_dwordx4 v10, s[24:27], s38 offen offset:0 lds
    s_waitcnt lgkmcnt(8)
    v_mfma_f32_32x32x16_bf16 v[40:55], a[136:139], a[24:27], v[40:55]
    ds_read_b64_tr_b16 a[8:9], v23 offset:9216
    ds_read_b64_tr_b16 a[10:11], v23 offset:9728
    v_mfma_f32_32x32x16_bf16 v[56:71], a[136:139], a[28:31], v[56:71]
    ds_read_b64_tr_b16 a[12:13], v24 offset:9216
    ds_read_b64_tr_b16 a[14:15], v24 offset:9728
    buffer_load_dwordx4 v11, s[24:27], s38 offen offset:1024 lds
    s_waitcnt lgkmcnt(8)
    v_mfma_f32_32x32x16_bf16 v[40:55], a[140:143], a[32:35], v[40:55]
    ds_read_b64_tr_b16 a[16:17], v21 offset:11264
    ds_read_b64_tr_b16 a[18:19], v21 offset:11776
    v_mfma_f32_32x32x16_bf16 v[56:71], a[140:143], a[36:39], v[56:71]
    ds_read_b64_tr_b16 a[20:21], v22 offset:11264
    ds_read_b64_tr_b16 a[22:23], v22 offset:11776
    buffer_load_dwordx4 v12, s[24:27], s38 offen offset:2048 lds
    s_waitcnt lgkmcnt(8)
    v_mfma_f32_32x32x16_bf16 v[72:87], a[128:131], a[0:3], v[72:87]
    ds_read_b64_tr_b16 a[24:25], v23 offset:11264
    ds_read_b64_tr_b16 a[26:27], v23 offset:11776
    v_mfma_f32_32x32x16_bf16 v[88:103], a[128:131], a[4:7], v[88:103]
    ds_read_b64_tr_b16 a[28:29], v24 offset:11264
    ds_read_b64_tr_b16 a[30:31], v24 offset:11776
    s_add_u32 m0, s49, 4096
    s_add_u32 s62, s35, s55
    buffer_load_dwordx4 v2, s[20:23], s62 offen offset:0 lds
    s_waitcnt lgkmcnt(8)
    v_mfma_f32_32x32x16_bf16 v[72:87], a[132:135], a[8:11], v[72:87]
    s_waitcnt vmcnt(28)
    s_barrier
    ds_read_b64_tr_b16 a[32:33], v25 offset:12288
    ds_read_b64_tr_b16 a[34:35], v25 offset:12544
    v_cvt_pk_bf16_f32 v192, v40, v41
    v_cvt_pk_bf16_f32 v193, v42, v43
    v_mfma_f32_32x32x16_bf16 v[88:103], a[132:135], a[12:15], v[88:103]
    ds_read_b64_tr_b16 a[36:37], v26 offset:12288
    ds_read_b64_tr_b16 a[38:39], v26 offset:12544
    buffer_load_dwordx4 v3, s[20:23], s62 offen offset:1024 lds
    v_cvt_pk_bf16_f32 v194, v44, v45
    v_cvt_pk_bf16_f32 v195, v46, v47
    s_waitcnt lgkmcnt(8)
    v_mfma_f32_32x32x16_bf16 v[72:87], a[136:139], a[16:19], v[72:87]
    ds_read_b64_tr_b16 a[0:1], v27 offset:12288
    ds_read_b64_tr_b16 a[2:3], v27 offset:12544
    v_cvt_pk_bf16_f32 v196, v48, v49
    v_cvt_pk_bf16_f32 v197, v50, v51
    v_cvt_pk_bf16_f32 v198, v52, v53
    v_cvt_pk_bf16_f32 v199, v54, v55
    v_mfma_f32_32x32x16_bf16 v[88:103], a[136:139], a[20:23], v[88:103]
    ds_read_b64_tr_b16 a[4:5], v28 offset:12288
    ds_read_b64_tr_b16 a[6:7], v28 offset:12544
    buffer_load_dwordx4 v4, s[20:23], s62 offen offset:2048 lds
    v_accvgpr_write_b32 a184, v192
    v_accvgpr_write_b32 a185, v193
    s_waitcnt lgkmcnt(8)
    v_mfma_f32_32x32x16_bf16 v[72:87], a[140:143], a[24:27], v[72:87]
    ds_read_b64_tr_b16 a[8:9], v25 offset:13312
    ds_read_b64_tr_b16 a[10:11], v25 offset:13568
    v_accvgpr_write_b32 a186, v194
    v_accvgpr_write_b32 a187, v195
    v_accvgpr_write_b32 a188, v196
    v_accvgpr_write_b32 a189, v197
    v_mfma_f32_32x32x16_bf16 v[88:103], a[140:143], a[28:31], v[88:103]
    ds_read_b64_tr_b16 a[12:13], v26 offset:13312
    ds_read_b64_tr_b16 a[14:15], v26 offset:13568
    buffer_load_dwordx4 v5, s[20:23], s62 offen offset:3072 lds
    v_accvgpr_write_b32 a190, v198
    v_accvgpr_write_b32 a191, v199
    s_waitcnt lgkmcnt(8)
    v_mfma_f32_32x32x16_bf16 v[104:119], a[96:99], a[32:35], 0
    ds_read_b64_tr_b16 a[16:17], v27 offset:13312
    ds_read_b64_tr_b16 a[18:19], v27 offset:13568
    v_cvt_pk_bf16_f32 v200, v56, v57
    v_cvt_pk_bf16_f32 v201, v58, v59
    v_cvt_pk_bf16_f32 v202, v60, v61
    v_cvt_pk_bf16_f32 v203, v62, v63
    v_mfma_f32_32x32x16_bf16 v[104:119], a[100:103], a[36:39], v[104:119]
    ds_read_b64_tr_b16 a[20:21], v28 offset:13312
    ds_read_b64_tr_b16 a[22:23], v28 offset:13568
    v_cvt_pk_bf16_f32 v204, v64, v65
    v_cvt_pk_bf16_f32 v205, v66, v67
    v_cvt_pk_bf16_f32 v206, v68, v69
    v_cvt_pk_bf16_f32 v207, v70, v71
    s_waitcnt lgkmcnt(8)
    v_mfma_f32_32x32x16_bf16 v[104:119], a[104:107], a[0:3], v[104:119]
    ds_read_b64_tr_b16 a[24:25], v25 offset:14336
    ds_read_b64_tr_b16 a[26:27], v25 offset:14592
    v_accvgpr_write_b32 a192, v200
    v_accvgpr_write_b32 a193, v201
    v_accvgpr_write_b32 a194, v202
    v_accvgpr_write_b32 a195, v203
    v_mfma_f32_32x32x16_bf16 v[104:119], a[108:111], a[4:7], v[104:119]
    ds_read_b64_tr_b16 a[28:29], v26 offset:14336
    ds_read_b64_tr_b16 a[30:31], v26 offset:14592
    v_accvgpr_write_b32 a196, v204
    v_accvgpr_write_b32 a197, v205
    v_accvgpr_write_b32 a198, v206
    v_accvgpr_write_b32 a199, v207
    s_waitcnt lgkmcnt(8)
    v_mfma_f32_32x32x16_bf16 v[104:119], a[112:115], a[8:11], v[104:119]
    ds_read_b64_tr_b16 a[32:33], v27 offset:14336
    ds_read_b64_tr_b16 a[34:35], v27 offset:14592
    v_cvt_pk_bf16_f32 v208, v72, v73
    v_cvt_pk_bf16_f32 v209, v74, v75
    v_cvt_pk_bf16_f32 v210, v76, v77
    v_cvt_pk_bf16_f32 v211, v78, v79
    v_mfma_f32_32x32x16_bf16 v[104:119], a[116:119], a[12:15], v[104:119]
    ds_read_b64_tr_b16 a[36:37], v28 offset:14336
    ds_read_b64_tr_b16 a[38:39], v28 offset:14592
    s_waitcnt vmcnt(27)
    ds_read_b128 a[48:51], v17 offset:15360
    ds_read_b128 a[52:55], v18 offset:15360
    v_cvt_pk_bf16_f32 v212, v80, v81
    s_waitcnt lgkmcnt(10)
    v_mfma_f32_32x32x16_bf16 v[104:119], a[120:123], a[16:19], v[104:119]
    s_waitcnt vmcnt(23)
    s_barrier
    ds_read_b64_tr_b16 a[0:1], v21 offset:19456
    ds_read_b64_tr_b16 a[2:3], v21 offset:19968
    ds_read_b128 a[56:59], v19 offset:15360
    v_cvt_pk_bf16_f32 v213, v82, v83
    v_mfma_f32_32x32x16_bf16 v[104:119], a[124:127], a[20:23], v[104:119]
    ds_read_b64_tr_b16 a[4:5], v22 offset:19456
    ds_read_b64_tr_b16 a[6:7], v22 offset:19968
    ds_read_b128 a[60:63], v20 offset:15360
    v_cvt_pk_bf16_f32 v214, v84, v85
    v_cvt_pk_bf16_f32 v215, v86, v87
    v_accvgpr_write_b32 a200, v208
    s_waitcnt lgkmcnt(12)
    v_mfma_f32_32x32x16_bf16 v[104:119], a[128:131], a[24:27], v[104:119]
    ds_read_b64_tr_b16 a[8:9], v23 offset:19456
    ds_read_b64_tr_b16 a[10:11], v23 offset:19968
    v_accvgpr_write_b32 a201, v209
    v_accvgpr_write_b32 a202, v210
    v_accvgpr_write_b32 a203, v211
    v_accvgpr_write_b32 a204, v212
    v_mfma_f32_32x32x16_bf16 v[104:119], a[132:135], a[28:31], v[104:119]
    ds_read_b64_tr_b16 a[12:13], v24 offset:19456
    ds_read_b64_tr_b16 a[14:15], v24 offset:19968
    s_add_u32 m0, s49, 8192
    s_add_u32 s62, s39, s58
    buffer_load_dwordx4 v6, s[24:27], s62 offen offset:0 lds
    s_waitcnt lgkmcnt(12)
    v_mfma_f32_32x32x16_bf16 v[104:119], a[136:139], a[32:35], v[104:119]
    ds_read_b64_tr_b16 a[16:17], v21 offset:20480
    ds_read_b64_tr_b16 a[18:19], v21 offset:20992
    v_accvgpr_write_b32 a205, v213
    v_accvgpr_write_b32 a206, v214
    v_accvgpr_write_b32 a207, v215
    v_cvt_pk_bf16_f32 v216, v88, v89
    v_mfma_f32_32x32x16_bf16 v[104:119], a[140:143], a[36:39], v[104:119]
    ds_read_b64_tr_b16 a[20:21], v22 offset:20480
    ds_read_b64_tr_b16 a[22:23], v22 offset:20992
    v_cvt_pk_bf16_f32 v217, v90, v91
    v_cvt_pk_bf16_f32 v218, v92, v93
    v_cvt_pk_bf16_f32 v219, v94, v95
    v_cvt_pk_bf16_f32 v220, v96, v97
    s_waitcnt lgkmcnt(9)
    v_mfma_f32_32x32x16_bf16 v[40:55], a[48:51], a[0:3], 0
    ds_read_b64_tr_b16 a[24:25], v23 offset:20480
    ds_read_b64_tr_b16 a[26:27], v23 offset:20992
    buffer_load_dwordx4 v7, s[24:27], s62 offen offset:1024 lds
    v_cvt_pk_bf16_f32 v221, v98, v99
    v_cvt_pk_bf16_f32 v222, v100, v101
    v_mfma_f32_32x32x16_bf16 v[56:71], a[48:51], a[4:7], 0
    ds_read_b64_tr_b16 a[28:29], v24 offset:20480
    ds_read_b64_tr_b16 a[30:31], v24 offset:20992
    v_cvt_pk_bf16_f32 v223, v102, v103
    v_accvgpr_write_b32 a208, v216
    v_accvgpr_write_b32 a209, v217
    v_accvgpr_write_b32 a210, v218
    s_waitcnt lgkmcnt(8)
    v_mfma_f32_32x32x16_bf16 v[40:55], a[52:55], a[8:11], v[40:55]
    ds_read_b64_tr_b16 a[32:33], v21 offset:21504
    ds_read_b64_tr_b16 a[34:35], v21 offset:22016
    v_accvgpr_write_b32 a211, v219
    v_accvgpr_write_b32 a212, v220
    v_accvgpr_write_b32 a213, v221
    v_accvgpr_write_b32 a214, v222
    v_mfma_f32_32x32x16_bf16 v[56:71], a[52:55], a[12:15], v[56:71]
    ds_read_b64_tr_b16 a[36:37], v22 offset:21504
    ds_read_b64_tr_b16 a[38:39], v22 offset:22016
    buffer_load_dwordx4 v8, s[24:27], s62 offen offset:2048 lds
    v_accvgpr_write_b32 a215, v223
    v_cvt_pk_bf16_f32 v224, v104, v105
    s_waitcnt lgkmcnt(8)
    v_mfma_f32_32x32x16_bf16 v[72:87], a[48:51], a[16:19], 0
    ds_read_b64_tr_b16 a[0:1], v23 offset:21504
    ds_read_b64_tr_b16 a[2:3], v23 offset:22016
    v_cvt_pk_bf16_f32 v225, v106, v107
    v_cvt_pk_bf16_f32 v226, v108, v109
    v_cvt_pk_bf16_f32 v227, v110, v111
    v_cvt_pk_bf16_f32 v228, v112, v113
    v_mfma_f32_32x32x16_bf16 v[88:103], a[48:51], a[20:23], 0
    ds_read_b64_tr_b16 a[4:5], v24 offset:21504
    ds_read_b64_tr_b16 a[6:7], v24 offset:22016
    v_cvt_pk_bf16_f32 v229, v114, v115
    v_cvt_pk_bf16_f32 v230, v116, v117
    v_cvt_pk_bf16_f32 v231, v118, v119
    v_accvgpr_write_b32 a216, v224
    s_waitcnt lgkmcnt(8)
    v_mfma_f32_32x32x16_bf16 v[72:87], a[52:55], a[24:27], v[72:87]
    ds_read_b64_tr_b16 a[8:9], v21 offset:22528
    ds_read_b64_tr_b16 a[10:11], v21 offset:23040
    buffer_load_dwordx4 v9, s[24:27], s62 offen offset:3072 lds
    v_accvgpr_write_b32 a217, v225
    v_accvgpr_write_b32 a218, v226
    v_mfma_f32_32x32x16_bf16 v[88:103], a[52:55], a[28:31], v[88:103]
    ds_read_b64_tr_b16 a[12:13], v22 offset:22528
    ds_read_b64_tr_b16 a[14:15], v22 offset:23040
    v_accvgpr_write_b32 a219, v227
    v_accvgpr_write_b32 a220, v228
    v_accvgpr_write_b32 a221, v229
    v_accvgpr_write_b32 a222, v230
    s_waitcnt lgkmcnt(8)
    v_mfma_f32_32x32x16_bf16 v[40:55], a[56:59], a[32:35], v[40:55]
    ds_read_b64_tr_b16 a[16:17], v23 offset:22528
    ds_read_b64_tr_b16 a[18:19], v23 offset:23040
    v_accvgpr_write_b32 a223, v231
    v_mfma_f32_32x32x16_bf16 v[56:71], a[56:59], a[36:39], v[56:71]
    ds_read_b64_tr_b16 a[20:21], v24 offset:22528
    ds_read_b64_tr_b16 a[22:23], v24 offset:23040
    s_waitcnt vmcnt(23)
    ds_read_b128 a[64:67], v17 offset:27648
    ds_read_b128 a[68:71], v18 offset:27648
    s_waitcnt lgkmcnt(10)
    v_mfma_f32_32x32x16_bf16 v[40:55], a[60:63], a[0:3], v[40:55]
    s_waitcnt vmcnt(19)
    s_barrier
    ds_read_b64_tr_b16 a[24:25], v21 offset:23552
    ds_read_b64_tr_b16 a[26:27], v21 offset:24064
    s_add_u32 m0, s49, 12288
    s_add_u32 s62, s35, s56
    buffer_load_dwordx4 v2, s[20:23], s62 offen offset:0 nt lds
    v_mfma_f32_32x32x16_bf16 v[56:71], a[60:63], a[4:7], v[56:71]
    ds_read_b64_tr_b16 a[28:29], v22 offset:23552
    ds_read_b64_tr_b16 a[30:31], v22 offset:24064
    ds_read_b128 a[72:75], v19 offset:27648
    ds_read_b128 a[76:79], v20 offset:27648
    s_waitcnt lgkmcnt(12)
    v_mfma_f32_32x32x16_bf16 v[72:87], a[56:59], a[8:11], v[72:87]
    ds_read_b64_tr_b16 a[32:33], v23 offset:23552
    ds_read_b64_tr_b16 a[34:35], v23 offset:24064
    v_mfma_f32_32x32x16_bf16 v[88:103], a[56:59], a[12:15], v[88:103]
    ds_read_b64_tr_b16 a[36:37], v24 offset:23552
    ds_read_b64_tr_b16 a[38:39], v24 offset:24064
    buffer_load_dwordx4 v3, s[20:23], s62 offen offset:1024 nt lds
    s_waitcnt lgkmcnt(12)
    v_mfma_f32_32x32x16_bf16 v[72:87], a[60:63], a[16:19], v[72:87]
    ds_read_b64_tr_b16 a[0:1], v21 offset:24576
    ds_read_b64_tr_b16 a[2:3], v21 offset:25088
    v_mfma_f32_32x32x16_bf16 v[88:103], a[60:63], a[20:23], v[88:103]
    ds_read_b64_tr_b16 a[4:5], v22 offset:24576
    ds_read_b64_tr_b16 a[6:7], v22 offset:25088
    s_waitcnt lgkmcnt(10)
    v_mfma_f32_32x32x16_bf16 v[40:55], a[64:67], a[24:27], v[40:55]
    ds_read_b64_tr_b16 a[8:9], v23 offset:24576
    ds_read_b64_tr_b16 a[10:11], v23 offset:25088
    buffer_load_dwordx4 v4, s[20:23], s62 offen offset:2048 nt lds
    v_mfma_f32_32x32x16_bf16 v[56:71], a[64:67], a[28:31], v[56:71]
    ds_read_b64_tr_b16 a[12:13], v24 offset:24576
    ds_read_b64_tr_b16 a[14:15], v24 offset:25088
    s_waitcnt lgkmcnt(8)
    v_mfma_f32_32x32x16_bf16 v[40:55], a[68:71], a[32:35], v[40:55]
    ds_read_b64_tr_b16 a[16:17], v21 offset:25600
    ds_read_b64_tr_b16 a[18:19], v21 offset:26112
    v_mfma_f32_32x32x16_bf16 v[56:71], a[68:71], a[36:39], v[56:71]
    ds_read_b64_tr_b16 a[20:21], v22 offset:25600
    ds_read_b64_tr_b16 a[22:23], v22 offset:26112
    buffer_load_dwordx4 v5, s[20:23], s62 offen offset:3072 nt lds
    s_waitcnt lgkmcnt(8)
    v_mfma_f32_32x32x16_bf16 v[72:87], a[64:67], a[0:3], v[72:87]
    ds_read_b64_tr_b16 a[24:25], v23 offset:25600
    ds_read_b64_tr_b16 a[26:27], v23 offset:26112
    v_mfma_f32_32x32x16_bf16 v[88:103], a[64:67], a[4:7], v[88:103]
    ds_read_b64_tr_b16 a[28:29], v24 offset:25600
    ds_read_b64_tr_b16 a[30:31], v24 offset:26112
    s_waitcnt lgkmcnt(8)
    v_mfma_f32_32x32x16_bf16 v[72:87], a[68:71], a[8:11], v[72:87]
    ds_read_b64_tr_b16 a[32:33], v21 offset:26624
    ds_read_b64_tr_b16 a[34:35], v21 offset:27136
    v_mfma_f32_32x32x16_bf16 v[88:103], a[68:71], a[12:15], v[88:103]
    ds_read_b64_tr_b16 a[36:37], v22 offset:26624
    ds_read_b64_tr_b16 a[38:39], v22 offset:27136
    s_add_u32 m0, s49, 16384
    s_add_u32 s62, s39, s59
    buffer_load_dwordx4 v6, s[24:27], s62 offen offset:0 nt lds
    s_waitcnt lgkmcnt(8)
    v_mfma_f32_32x32x16_bf16 v[40:55], a[72:75], a[16:19], v[40:55]
    ds_read_b64_tr_b16 a[0:1], v23 offset:26624
    ds_read_b64_tr_b16 a[2:3], v23 offset:27136
    v_mfma_f32_32x32x16_bf16 v[56:71], a[72:75], a[20:23], v[56:71]
    ds_read_b64_tr_b16 a[4:5], v24 offset:26624
    ds_read_b64_tr_b16 a[6:7], v24 offset:27136
    s_waitcnt vmcnt(20)
    ds_read_b128 a[80:83], v17 offset:35840
    ds_read_b128 a[84:87], v18 offset:35840
    s_waitcnt lgkmcnt(10)
    v_mfma_f32_32x32x16_bf16 v[40:55], a[76:79], a[24:27], v[40:55]
    s_waitcnt vmcnt(16)
    s_barrier
    ds_read_b64_tr_b16 a[8:9], v21 offset:31744
    ds_read_b64_tr_b16 a[10:11], v21 offset:32256
    buffer_load_dwordx4 v7, s[24:27], s62 offen offset:1024 nt lds
    v_mfma_f32_32x32x16_bf16 v[56:71], a[76:79], a[28:31], v[56:71]
    ds_read_b64_tr_b16 a[12:13], v22 offset:31744
    ds_read_b64_tr_b16 a[14:15], v22 offset:32256
    ds_read_b128 a[88:91], v19 offset:35840
    ds_read_b128 a[92:95], v20 offset:35840
    s_waitcnt lgkmcnt(12)
    v_mfma_f32_32x32x16_bf16 v[72:87], a[72:75], a[32:35], v[72:87]
    ds_read_b64_tr_b16 a[16:17], v23 offset:31744
    ds_read_b64_tr_b16 a[18:19], v23 offset:32256
    v_mfma_f32_32x32x16_bf16 v[88:103], a[72:75], a[36:39], v[88:103]
    ds_read_b64_tr_b16 a[20:21], v24 offset:31744
    ds_read_b64_tr_b16 a[22:23], v24 offset:32256
    buffer_load_dwordx4 v8, s[24:27], s62 offen offset:2048 nt lds
    s_waitcnt lgkmcnt(12)
    v_mfma_f32_32x32x16_bf16 v[72:87], a[76:79], a[0:3], v[72:87]
    ds_read_b64_tr_b16 a[24:25], v21 offset:33792
    ds_read_b64_tr_b16 a[26:27], v21 offset:34304
    v_mfma_f32_32x32x16_bf16 v[88:103], a[76:79], a[4:7], v[88:103]
    ds_read_b64_tr_b16 a[28:29], v22 offset:33792
    ds_read_b64_tr_b16 a[30:31], v22 offset:34304
    s_waitcnt lgkmcnt(10)
    v_mfma_f32_32x32x16_bf16 v[40:55], a[80:83], a[8:11], v[40:55]
    ds_read_b64_tr_b16 a[32:33], v23 offset:33792
    ds_read_b64_tr_b16 a[34:35], v23 offset:34304
    buffer_load_dwordx4 v9, s[24:27], s62 offen offset:3072 nt lds
    v_mfma_f32_32x32x16_bf16 v[56:71], a[80:83], a[12:15], v[56:71]
    ds_read_b64_tr_b16 a[36:37], v24 offset:33792
    ds_read_b64_tr_b16 a[38:39], v24 offset:34304
    s_waitcnt lgkmcnt(8)
    v_mfma_f32_32x32x16_bf16 v[40:55], a[84:87], a[16:19], v[40:55]
    ds_read_b64_tr_b16 a[0:1], v21 offset:32768
    ds_read_b64_tr_b16 a[2:3], v21 offset:33280
    v_mfma_f32_32x32x16_bf16 v[56:71], a[84:87], a[20:23], v[56:71]
    ds_read_b64_tr_b16 a[4:5], v22 offset:32768
    ds_read_b64_tr_b16 a[6:7], v22 offset:33280
    s_waitcnt lgkmcnt(8)
    v_mfma_f32_32x32x16_bf16 v[40:55], a[88:91], a[24:27], v[40:55]
    ds_read_b64_tr_b16 a[8:9], v23 offset:32768
    ds_read_b64_tr_b16 a[10:11], v23 offset:33280
    s_add_u32 m0, s49, 20480
    s_add_u32 s62, s35, s57
    buffer_load_dwordx4 v2, s[20:23], s62 offen offset:0 nt lds
    v_mfma_f32_32x32x16_bf16 v[56:71], a[88:91], a[28:31], v[56:71]
    ds_read_b64_tr_b16 a[12:13], v24 offset:32768
    ds_read_b64_tr_b16 a[14:15], v24 offset:33280
    s_waitcnt lgkmcnt(8)
    v_mfma_f32_32x32x16_bf16 v[40:55], a[92:95], a[32:35], v[40:55]
    ds_read_b64_tr_b16 a[16:17], v21 offset:34816
    ds_read_b64_tr_b16 a[18:19], v21 offset:35328
    v_mfma_f32_32x32x16_bf16 v[56:71], a[92:95], a[36:39], v[56:71]
    ds_read_b64_tr_b16 a[20:21], v22 offset:34816
    ds_read_b64_tr_b16 a[22:23], v22 offset:35328
    buffer_load_dwordx4 v3, s[20:23], s62 offen offset:1024 nt lds
    s_waitcnt lgkmcnt(8)
    v_mfma_f32_32x32x16_bf16 v[72:87], a[80:83], a[0:3], v[72:87]
    ds_read_b64_tr_b16 a[24:25], v23 offset:34816
    ds_read_b64_tr_b16 a[26:27], v23 offset:35328
    v_mfma_f32_32x32x16_bf16 v[88:103], a[80:83], a[4:7], v[88:103]
    ds_read_b64_tr_b16 a[28:29], v24 offset:34816
    ds_read_b64_tr_b16 a[30:31], v24 offset:35328
    v_cvt_pk_bf16_f32 v120, v40, v41
    v_cvt_pk_bf16_f32 v121, v42, v43
    v_cvt_pk_bf16_f32 v122, v44, v45
    v_cvt_pk_bf16_f32 v123, v46, v47
    s_waitcnt lgkmcnt(8)
    v_mfma_f32_32x32x16_bf16 v[72:87], a[84:87], a[8:11], v[72:87]
    s_waitcnt vmcnt(18)
    s_barrier
    ds_read_b64_tr_b16 a[32:33], v25 offset:0
    ds_read_b64_tr_b16 a[34:35], v25 offset:256
    buffer_load_dwordx4 v4, s[20:23], s62 offen offset:2048 nt lds
    v_mfma_f32_32x32x16_bf16 v[88:103], a[84:87], a[12:15], v[88:103]
    ds_read_b64_tr_b16 a[36:37], v26 offset:0
    ds_read_b64_tr_b16 a[38:39], v26 offset:256
    v_cvt_pk_bf16_f32 v124, v48, v49
    v_cvt_pk_bf16_f32 v125, v50, v51
    v_cvt_pk_bf16_f32 v126, v52, v53
    v_cvt_pk_bf16_f32 v127, v54, v55
    s_waitcnt lgkmcnt(8)
    v_mfma_f32_32x32x16_bf16 v[72:87], a[88:91], a[16:19], v[72:87]
    ds_read_b64_tr_b16 a[0:1], v27 offset:0
    ds_read_b64_tr_b16 a[2:3], v27 offset:256
    v_cvt_pk_bf16_f32 v128, v56, v57
    v_cvt_pk_bf16_f32 v129, v58, v59
    v_cvt_pk_bf16_f32 v130, v60, v61
    v_cvt_pk_bf16_f32 v131, v62, v63
    v_mfma_f32_32x32x16_bf16 v[88:103], a[88:91], a[20:23], v[88:103]
    ds_read_b64_tr_b16 a[4:5], v28 offset:0
    ds_read_b64_tr_b16 a[6:7], v28 offset:256
    buffer_load_dwordx4 v5, s[20:23], s62 offen offset:3072 nt lds
    v_cvt_pk_bf16_f32 v132, v64, v65
    v_cvt_pk_bf16_f32 v133, v66, v67
    s_waitcnt lgkmcnt(8)
    v_mfma_f32_32x32x16_bf16 v[72:87], a[92:95], a[24:27], v[72:87]
    ds_read_b64_tr_b16 a[8:9], v25 offset:1024
    ds_read_b64_tr_b16 a[10:11], v25 offset:1280
    v_cvt_pk_bf16_f32 v134, v68, v69
    v_cvt_pk_bf16_f32 v135, v70, v71
    v_mfma_f32_32x32x16_bf16 v[88:103], a[92:95], a[28:31], v[88:103]
    ds_read_b64_tr_b16 a[12:13], v26 offset:1024
    ds_read_b64_tr_b16 a[14:15], v26 offset:1280
    s_waitcnt lgkmcnt(8)
    v_mfma_f32_32x32x16_bf16 v[104:119], a[48:51], a[32:35], 0
    ds_read_b64_tr_b16 a[16:17], v27 offset:1024
    ds_read_b64_tr_b16 a[18:19], v27 offset:1280
    s_add_u32 m0, s49, 24576
    s_add_u32 s62, s39, s60
    buffer_load_dwordx4 v6, s[24:27], s62 offen offset:0 nt lds
    v_mfma_f32_32x32x16_bf16 v[104:119], a[52:55], a[36:39], v[104:119]
    ds_read_b64_tr_b16 a[20:21], v28 offset:1024
    ds_read_b64_tr_b16 a[22:23], v28 offset:1280
    v_cvt_pk_bf16_f32 v136, v72, v73
    v_cvt_pk_bf16_f32 v137, v74, v75
    v_cvt_pk_bf16_f32 v138, v76, v77
    v_cvt_pk_bf16_f32 v139, v78, v79
    s_waitcnt lgkmcnt(8)
    v_mfma_f32_32x32x16_bf16 v[104:119], a[56:59], a[0:3], v[104:119]
    ds_read_b64_tr_b16 a[24:25], v25 offset:2048
    ds_read_b64_tr_b16 a[26:27], v25 offset:2304
    v_cvt_pk_bf16_f32 v140, v80, v81
    v_cvt_pk_bf16_f32 v141, v82, v83
    v_cvt_pk_bf16_f32 v142, v84, v85
    v_cvt_pk_bf16_f32 v143, v86, v87
    v_mfma_f32_32x32x16_bf16 v[104:119], a[60:63], a[4:7], v[104:119]
    ds_read_b64_tr_b16 a[28:29], v26 offset:2048
    ds_read_b64_tr_b16 a[30:31], v26 offset:2304
    v_cvt_pk_bf16_f32 v144, v88, v89
    v_cvt_pk_bf16_f32 v145, v90, v91
    v_cvt_pk_bf16_f32 v146, v92, v93
    v_cvt_pk_bf16_f32 v147, v94, v95
    s_waitcnt lgkmcnt(8)
    v_mfma_f32_32x32x16_bf16 v[104:119], a[64:67], a[8:11], v[104:119]
    ds_read_b64_tr_b16 a[32:33], v27 offset:2048
    ds_read_b64_tr_b16 a[34:35], v27 offset:2304
    buffer_load_dwordx4 v7, s[24:27], s62 offen offset:1024 nt lds
    v_cvt_pk_bf16_f32 v148, v96, v97
    v_cvt_pk_bf16_f32 v149, v98, v99
    v_mfma_f32_32x32x16_bf16 v[104:119], a[68:71], a[12:15], v[104:119]
    ds_read_b64_tr_b16 a[36:37], v28 offset:2048
    ds_read_b64_tr_b16 a[38:39], v28 offset:2304
    s_waitcnt vmcnt(18)
    ds_read_b128 a[96:99], v17 offset:4096
    ds_read_b128 a[100:103], v18 offset:4096
    v_cvt_pk_bf16_f32 v150, v100, v101
    s_waitcnt lgkmcnt(10)
    v_mfma_f32_32x32x16_bf16 v[104:119], a[72:75], a[16:19], v[104:119]
    s_waitcnt vmcnt(14)
    s_barrier
    ds_read_b64_tr_b16 a[0:1], v21 offset:8192
    ds_read_b64_tr_b16 a[2:3], v21 offset:8704
    ds_read_b128 a[104:107], v19 offset:4096
    v_cvt_pk_bf16_f32 v151, v102, v103
    v_mfma_f32_32x32x16_bf16 v[104:119], a[76:79], a[20:23], v[104:119]
    ds_read_b64_tr_b16 a[4:5], v22 offset:8192
    ds_read_b64_tr_b16 a[6:7], v22 offset:8704
    buffer_load_dwordx4 v8, s[24:27], s62 offen offset:2048 nt lds
    ds_read_b128 a[108:111], v20 offset:4096
    s_waitcnt lgkmcnt(12)
    v_mfma_f32_32x32x16_bf16 v[104:119], a[80:83], a[24:27], v[104:119]
    ds_read_b64_tr_b16 a[8:9], v23 offset:8192
    ds_read_b64_tr_b16 a[10:11], v23 offset:8704
    v_mfma_f32_32x32x16_bf16 v[104:119], a[84:87], a[28:31], v[104:119]
    ds_read_b64_tr_b16 a[12:13], v24 offset:8192
    ds_read_b64_tr_b16 a[14:15], v24 offset:8704
    s_waitcnt lgkmcnt(12)
    v_mfma_f32_32x32x16_bf16 v[104:119], a[88:91], a[32:35], v[104:119]
    ds_read_b64_tr_b16 a[16:17], v21 offset:9216
    ds_read_b64_tr_b16 a[18:19], v21 offset:9728
    buffer_load_dwordx4 v9, s[24:27], s62 offen offset:3072 nt lds
    v_mfma_f32_32x32x16_bf16 v[104:119], a[92:95], a[36:39], v[104:119]
    ds_read_b64_tr_b16 a[20:21], v22 offset:9216
    ds_read_b64_tr_b16 a[22:23], v22 offset:9728
    s_waitcnt lgkmcnt(9)
    v_mfma_f32_32x32x16_bf16 v[40:55], a[96:99], a[0:3], 0
    ds_read_b64_tr_b16 a[24:25], v23 offset:9216
    ds_read_b64_tr_b16 a[26:27], v23 offset:9728
    v_mfma_f32_32x32x16_bf16 v[56:71], a[96:99], a[4:7], 0
    ds_read_b64_tr_b16 a[28:29], v24 offset:9216
    ds_read_b64_tr_b16 a[30:31], v24 offset:9728
    s_add_u32 m0, s49, 28672
    s_nop 0
    buffer_load_dwordx4 v10, s[24:27], s39 offen offset:0 nt lds
    v_cvt_pk_bf16_f32 v152, v104, v105
    s_waitcnt lgkmcnt(8)
    v_mfma_f32_32x32x16_bf16 v[40:55], a[100:103], a[8:11], v[40:55]
    ds_read_b64_tr_b16 a[32:33], v21 offset:10240
    ds_read_b64_tr_b16 a[34:35], v21 offset:10752
    v_cvt_pk_bf16_f32 v153, v106, v107
    v_cvt_pk_bf16_f32 v154, v108, v109
    v_cvt_pk_bf16_f32 v155, v110, v111
    v_cvt_pk_bf16_f32 v156, v112, v113
    v_mfma_f32_32x32x16_bf16 v[56:71], a[100:103], a[12:15], v[56:71]
    s_branch .LskB2
.p2align 12
.LstB2:
    s_branch .LmB
.LskB2:
    ds_read_b64_tr_b16 a[36:37], v22 offset:10240
    ds_read_b64_tr_b16 a[38:39], v22 offset:10752
    v_cvt_pk_bf16_f32 v157, v114, v115
    v_cvt_pk_bf16_f32 v158, v116, v117
    v_cvt_pk_bf16_f32 v159, v118, v119
    s_waitcnt lgkmcnt(8)
    v_mfma_f32_32x32x16_bf16 v[72:87], a[96:99], a[16:19], 0
    ds_read_b64_tr_b16 a[0:1], v23 offset:10240
    ds_read_b64_tr_b16 a[2:3], v23 offset:10752
    v_mfma_f32_32x32x16_bf16 v[88:103], a[96:99], a[20:23], 0
    ds_read_b64_tr_b16 a[4:5], v24 offset:10240
    ds_read_b64_tr_b16 a[6:7], v24 offset:10752
    buffer_load_dwordx4 v11, s[24:27], s39 offen offset:1024 nt lds
    s_waitcnt lgkmcnt(8)
    v_mfma_f32_32x32x16_bf16 v[72:87], a[100:103], a[24:27], v[72:87]
    ds_read_b64_tr_b16 a[8:9], v21 offset:11264
    ds_read_b64_tr_b16 a[10:11], v21 offset:11776
    v_mfma_f32_32x32x16_bf16 v[88:103], a[100:103], a[28:31], v[88:103]
    ds_read_b64_tr_b16 a[12:13], v22 offset:11264
    ds_read_b64_tr_b16 a[14:15], v22 offset:11776
    s_waitcnt lgkmcnt(8)
    v_mfma_f32_32x32x16_bf16 v[40:55], a[104:107], a[32:35], v[40:55]
    ds_read_b64_tr_b16 a[16:17], v23 offset:11264
    ds_read_b64_tr_b16 a[18:19], v23 offset:11776
    buffer_load_dwordx4 v12, s[24:27], s39 offen offset:2048 nt lds
    v_mfma_f32_32x32x16_bf16 v[56:71], a[104:107], a[36:39], v[56:71]
    ds_read_b64_tr_b16 a[20:21], v24 offset:11264
    ds_read_b64_tr_b16 a[22:23], v24 offset:11776
    s_waitcnt vmcnt(15)
    ds_read_b128 a[112:115], v17 offset:12288
    ds_read_b128 a[116:119], v18 offset:12288
    s_waitcnt lgkmcnt(10)
    v_mfma_f32_32x32x16_bf16 v[40:55], a[108:111], a[0:3], v[40:55]
    s_waitcnt vmcnt(11)
    s_barrier
    ds_read_b64_tr_b16 a[24:25], v21 offset:16384
    ds_read_b64_tr_b16 a[26:27], v21 offset:16896
    ds_read_b128 a[120:123], v19 offset:12288
    v_mfma_f32_32x32x16_bf16 v[56:71], a[108:111], a[4:7], v[56:71]
    ds_read_b64_tr_b16 a[28:29], v22 offset:16384
    ds_read_b64_tr_b16 a[30:31], v22 offset:16896
    ds_read_b128 a[124:127], v20 offset:12288
    s_waitcnt lgkmcnt(12)
    v_mfma_f32_32x32x16_bf16 v[72:87], a[104:107], a[8:11], v[72:87]
    ds_read_b64_tr_b16 a[32:33], v23 offset:16384
    ds_read_b64_tr_b16 a[34:35], v23 offset:16896
    v_mfma_f32_32x32x16_bf16 v[88:103], a[104:107], a[12:15], v[88:103]
    ds_read_b64_tr_b16 a[36:37], v24 offset:16384
    ds_read_b64_tr_b16 a[38:39], v24 offset:16896
    s_waitcnt lgkmcnt(12)
    v_mfma_f32_32x32x16_bf16 v[72:87], a[108:111], a[16:19], v[72:87]
    ds_read_b64_tr_b16 a[0:1], v21 offset:17408
    ds_read_b64_tr_b16 a[2:3], v21 offset:17920
    v_mfma_f32_32x32x16_bf16 v[88:103], a[108:111], a[20:23], v[88:103]
    ds_read_b64_tr_b16 a[4:5], v22 offset:17408
    ds_read_b64_tr_b16 a[6:7], v22 offset:17920
    s_waitcnt lgkmcnt(9)
    v_mfma_f32_32x32x16_bf16 v[40:55], a[112:115], a[24:27], v[40:55]
    ds_read_b64_tr_b16 a[8:9], v23 offset:17408
    ds_read_b64_tr_b16 a[10:11], v23 offset:17920
    v_mfma_f32_32x32x16_bf16 v[56:71], a[112:115], a[28:31], v[56:71]
    ds_read_b64_tr_b16 a[12:13], v24 offset:17408
    ds_read_b64_tr_b16 a[14:15], v24 offset:17920
    s_waitcnt lgkmcnt(8)
    v_mfma_f32_32x32x16_bf16 v[40:55], a[116:119], a[32:35], v[40:55]
    ds_read_b64_tr_b16 a[16:17], v21 offset:18432
    ds_read_b64_tr_b16 a[18:19], v21 offset:18944
    v_mfma_f32_32x32x16_bf16 v[56:71], a[116:119], a[36:39], v[56:71]
    ds_read_b64_tr_b16 a[20:21], v22 offset:18432
    ds_read_b64_tr_b16 a[22:23], v22 offset:18944
    s_waitcnt lgkmcnt(8)
    v_mfma_f32_32x32x16_bf16 v[72:87], a[112:115], a[0:3], v[72:87]
    ds_read_b64_tr_b16 a[24:25], v23 offset:18432
    ds_read_b64_tr_b16 a[26:27], v23 offset:18944
    v_mfma_f32_32x32x16_bf16 v[88:103], a[112:115], a[4:7], v[88:103]
    ds_read_b64_tr_b16 a[28:29], v24 offset:18432
    ds_read_b64_tr_b16 a[30:31], v24 offset:18944
    s_waitcnt lgkmcnt(8)
    v_mfma_f32_32x32x16_bf16 v[72:87], a[116:119], a[8:11], v[72:87]
    ds_read_b64_tr_b16 a[32:33], v21 offset:19456
    ds_read_b64_tr_b16 a[34:35], v21 offset:19968
    v_mfma_f32_32x32x16_bf16 v[88:103], a[116:119], a[12:15], v[88:103]
    ds_read_b64_tr_b16 a[36:37], v22 offset:19456
    ds_read_b64_tr_b16 a[38:39], v22 offset:19968
    s_waitcnt lgkmcnt(8)
    v_mfma_f32_32x32x16_bf16 v[40:55], a[120:123], a[16:19], v[40:55]
    ds_read_b64_tr_b16 a[0:1], v23 offset:19456
    ds_read_b64_tr_b16 a[2:3], v23 offset:19968
    v_mfma_f32_32x32x16_bf16 v[56:71], a[120:123], a[20:23], v[56:71]
    ds_read_b64_tr_b16 a[4:5], v24 offset:19456
    ds_read_b64_tr_b16 a[6:7], v24 offset:19968
    s_waitcnt vmcnt(7)
    ds_read_b128 a[128:131], v17 offset:20480
    ds_read_b128 a[132:135], v18 offset:20480
    s_waitcnt lgkmcnt(10)
    v_mfma_f32_32x32x16_bf16 v[40:55], a[124:127], a[24:27], v[40:55]
    s_waitcnt vmcnt(0)
    s_barrier
    ds_read_b64_tr_b16 a[8:9], v21 offset:24576
    ds_read_b64_tr_b16 a[10:11], v21 offset:25088
    ds_read_b128 a[136:139], v19 offset:20480
    v_mfma_f32_32x32x16_bf16 v[56:71], a[124:127], a[28:31], v[56:71]
    ds_read_b64_tr_b16 a[12:13], v22 offset:24576
    ds_read_b64_tr_b16 a[14:15], v22 offset:25088
    ds_read_b128 a[140:143], v20 offset:20480
    s_waitcnt lgkmcnt(12)
    v_mfma_f32_32x32x16_bf16 v[72:87], a[120:123], a[32:35], v[72:87]
    ds_read_b64_tr_b16 a[16:17], v23 offset:24576
    ds_read_b64_tr_b16 a[18:19], v23 offset:25088
    v_mfma_f32_32x32x16_bf16 v[88:103], a[120:123], a[36:39], v[88:103]
    ds_read_b64_tr_b16 a[20:21], v24 offset:24576
    ds_read_b64_tr_b16 a[22:23], v24 offset:25088
    s_waitcnt lgkmcnt(12)
    v_mfma_f32_32x32x16_bf16 v[72:87], a[124:127], a[0:3], v[72:87]
    ds_read_b64_tr_b16 a[24:25], v21 offset:26624
    ds_read_b64_tr_b16 a[26:27], v21 offset:27136
    v_mfma_f32_32x32x16_bf16 v[88:103], a[124:127], a[4:7], v[88:103]
    ds_read_b64_tr_b16 a[28:29], v22 offset:26624
    ds_read_b64_tr_b16 a[30:31], v22 offset:27136
    s_waitcnt lgkmcnt(9)
    v_mfma_f32_32x32x16_bf16 v[40:55], a[128:131], a[8:11], v[40:55]
    ds_read_b64_tr_b16 a[32:33], v23 offset:26624
    ds_read_b64_tr_b16 a[34:35], v23 offset:27136
    v_mfma_f32_32x32x16_bf16 v[56:71], a[128:131], a[12:15], v[56:71]
    ds_read_b64_tr_b16 a[36:37], v24 offset:26624
    ds_read_b64_tr_b16 a[38:39], v24 offset:27136
    s_waitcnt lgkmcnt(8)
    v_mfma_f32_32x32x16_bf16 v[40:55], a[132:135], a[16:19], v[40:55]
    ds_read_b64_tr_b16 a[0:1], v21 offset:25600
    ds_read_b64_tr_b16 a[2:3], v21 offset:26112
    v_mfma_f32_32x32x16_bf16 v[56:71], a[132:135], a[20:23], v[56:71]
    ds_read_b64_tr_b16 a[4:5], v22 offset:25600
    ds_read_b64_tr_b16 a[6:7], v22 offset:26112
    s_waitcnt lgkmcnt(8)
    v_mfma_f32_32x32x16_bf16 v[40:55], a[136:139], a[24:27], v[40:55]
    ds_read_b64_tr_b16 a[8:9], v23 offset:25600
    ds_read_b64_tr_b16 a[10:11], v23 offset:26112
    v_mfma_f32_32x32x16_bf16 v[56:71], a[136:139], a[28:31], v[56:71]
    ds_read_b64_tr_b16 a[12:13], v24 offset:25600
    ds_read_b64_tr_b16 a[14:15], v24 offset:26112
    s_waitcnt lgkmcnt(8)
    v_mfma_f32_32x32x16_bf16 v[40:55], a[140:143], a[32:35], v[40:55]
    ds_read_b64_tr_b16 a[16:17], v21 offset:27648
    ds_read_b64_tr_b16 a[18:19], v21 offset:28160
    v_mfma_f32_32x32x16_bf16 v[56:71], a[140:143], a[36:39], v[56:71]
    ds_read_b64_tr_b16 a[20:21], v22 offset:27648
    ds_read_b64_tr_b16 a[22:23], v22 offset:28160
    s_waitcnt lgkmcnt(8)
    v_mfma_f32_32x32x16_bf16 v[72:87], a[128:131], a[0:3], v[72:87]
    ds_read_b64_tr_b16 a[24:25], v23 offset:27648
    ds_read_b64_tr_b16 a[26:27], v23 offset:28160
    v_mfma_f32_32x32x16_bf16 v[88:103], a[128:131], a[4:7], v[88:103]
    ds_read_b64_tr_b16 a[28:29], v24 offset:27648
    ds_read_b64_tr_b16 a[30:31], v24 offset:28160
    v_cvt_pk_bf16_f32 v40, v40, v41
    v_cvt_pk_bf16_f32 v41, v42, v43
    v_cvt_pk_bf16_f32 v42, v44, v45
    v_cvt_pk_bf16_f32 v43, v46, v47
    s_waitcnt lgkmcnt(8)
    v_mfma_f32_32x32x16_bf16 v[72:87], a[132:135], a[8:11], v[72:87]
    ds_read_b64_tr_b16 a[32:33], v25 offset:28672
    ds_read_b64_tr_b16 a[34:35], v25 offset:28928
    v_cvt_pk_bf16_f32 v44, v48, v49
    v_cvt_pk_bf16_f32 v45, v50, v51
    v_cvt_pk_bf16_f32 v46, v52, v53
    v_cvt_pk_bf16_f32 v47, v54, v55
    v_mfma_f32_32x32x16_bf16 v[88:103], a[132:135], a[12:15], v[88:103]
    ds_read_b64_tr_b16 a[36:37], v26 offset:28672
    ds_read_b64_tr_b16 a[38:39], v26 offset:28928
    v_cvt_pk_bf16_f32 v48, v56, v57
    v_cvt_pk_bf16_f32 v49, v58, v59
    v_cvt_pk_bf16_f32 v50, v60, v61
    v_cvt_pk_bf16_f32 v51, v62, v63
    s_waitcnt lgkmcnt(8)
    v_mfma_f32_32x32x16_bf16 v[72:87], a[136:139], a[16:19], v[72:87]
    ds_read_b64_tr_b16 a[0:1], v27 offset:28672
    ds_read_b64_tr_b16 a[2:3], v27 offset:28928
    v_cvt_pk_bf16_f32 v52, v64, v65
    v_cvt_pk_bf16_f32 v53, v66, v67
    v_cvt_pk_bf16_f32 v54, v68, v69
    v_cvt_pk_bf16_f32 v55, v70, v71
    v_mfma_f32_32x32x16_bf16 v[88:103], a[136:139], a[20:23], v[88:103]
    ds_read_b64_tr_b16 a[4:5], v28 offset:28672
    ds_read_b64_tr_b16 a[6:7], v28 offset:28928
    s_waitcnt lgkmcnt(8)
    v_mfma_f32_32x32x16_bf16 v[72:87], a[140:143], a[24:27], v[72:87]
    ds_read_b64_tr_b16 a[8:9], v25 offset:29696
    ds_read_b64_tr_b16 a[10:11], v25 offset:29952
    v_mfma_f32_32x32x16_bf16 v[88:103], a[140:143], a[28:31], v[88:103]
    ds_read_b64_tr_b16 a[12:13], v26 offset:29696
    ds_read_b64_tr_b16 a[14:15], v26 offset:29952
    s_waitcnt lgkmcnt(8)
    v_mfma_f32_32x32x16_bf16 v[104:119], a[96:99], a[32:35], 0
    ds_read_b64_tr_b16 a[16:17], v27 offset:29696
    ds_read_b64_tr_b16 a[18:19], v27 offset:29952
    v_mfma_f32_32x32x16_bf16 v[104:119], a[100:103], a[36:39], v[104:119]
    ds_read_b64_tr_b16 a[20:21], v28 offset:29696
    ds_read_b64_tr_b16 a[22:23], v28 offset:29952
    v_cvt_pk_bf16_f32 v72, v72, v73
    v_cvt_pk_bf16_f32 v73, v74, v75
    v_cvt_pk_bf16_f32 v74, v76, v77
    v_cvt_pk_bf16_f32 v75, v78, v79
    s_waitcnt lgkmcnt(8)
    v_mfma_f32_32x32x16_bf16 v[104:119], a[104:107], a[0:3], v[104:119]
    ds_read_b64_tr_b16 a[24:25], v25 offset:30720
    ds_read_b64_tr_b16 a[26:27], v25 offset:30976
    v_cvt_pk_bf16_f32 v76, v80, v81
    v_cvt_pk_bf16_f32 v77, v82, v83
    v_cvt_pk_bf16_f32 v78, v84, v85
    v_cvt_pk_bf16_f32 v79, v86, v87
    v_mfma_f32_32x32x16_bf16 v[104:119], a[108:111], a[4:7], v[104:119]
    ds_read_b64_tr_b16 a[28:29], v26 offset:30720
    ds_read_b64_tr_b16 a[30:31], v26 offset:30976
    v_cvt_pk_bf16_f32 v88, v88, v89
    v_cvt_pk_bf16_f32 v89, v90, v91
    v_cvt_pk_bf16_f32 v90, v92, v93
    v_cvt_pk_bf16_f32 v91, v94, v95
    s_waitcnt lgkmcnt(8)
    v_mfma_f32_32x32x16_bf16 v[104:119], a[112:115], a[8:11], v[104:119]
    ds_read_b64_tr_b16 a[32:33], v27 offset:30720
    ds_read_b64_tr_b16 a[34:35], v27 offset:30976
    v_cvt_pk_bf16_f32 v92, v96, v97
    v_cvt_pk_bf16_f32 v93, v98, v99
    v_cvt_pk_bf16_f32 v94, v100, v101
    v_cvt_pk_bf16_f32 v95, v102, v103
    v_mfma_f32_32x32x16_bf16 v[104:119], a[116:119], a[12:15], v[104:119]
    ds_read_b64_tr_b16 a[36:37], v28 offset:30720
    ds_read_b64_tr_b16 a[38:39], v28 offset:30976
    buffer_load_dwordx4 v[160:163], v0, s[40:43], s44 offen offset:0 sc1
    buffer_load_dwordx4 v[164:167], v0, s[40:43], s44 offen offset:1024 sc1
    s_waitcnt lgkmcnt(8)
    v_mfma_f32_32x32x16_bf16 v[104:119], a[120:123], a[16:19], v[104:119]
    buffer_load_dwordx4 v[168:171], v0, s[40:43], s45 offen offset:0 sc1
    buffer_load_dwordx4 v[172:175], v0, s[40:43], s45 offen offset:1024 sc1
    buffer_load_dwordx4 v[176:179], v0, s[40:43], s46 offen offset:0 sc1
    v_mfma_f32_32x32x16_bf16 v[104:119], a[124:127], a[20:23], v[104:119]
    buffer_load_dwordx4 v[180:183], v0, s[40:43], s46 offen offset:1024 sc1
    buffer_load_dwordx4 v[184:187], v0, s[40:43], s47 offen offset:0 sc1
    buffer_load_dwordx4 v[188:191], v0, s[40:43], s47 offen offset:1024 sc1
    s_waitcnt lgkmcnt(4)
    v_mfma_f32_32x32x16_bf16 v[104:119], a[128:131], a[24:27], v[104:119]
    v_mfma_f32_32x32x16_bf16 v[104:119], a[132:135], a[28:31], v[104:119]
    s_waitcnt lgkmcnt(0)
    v_mfma_f32_32x32x16_bf16 v[104:119], a[136:139], a[32:35], v[104:119]
    v_mfma_f32_32x32x16_bf16 v[104:119], a[140:143], a[36:39], v[104:119]
    s_nop 11
    v_cvt_pk_bf16_f32 v104, v104, v105
    v_cvt_pk_bf16_f32 v105, v106, v107
    v_cvt_pk_bf16_f32 v106, v108, v109
    v_cvt_pk_bf16_f32 v107, v110, v111
    v_cvt_pk_bf16_f32 v108, v112, v113
    v_cvt_pk_bf16_f32 v109, v114, v115
    v_cvt_pk_bf16_f32 v110, v116, v117
    v_cvt_pk_bf16_f32 v111, v118, v119
    s_mov_b32 s3, 65536
    s_branch .Lpp
.Lpretry:
    s_sub_u32 s3, s3, 1
    s_cbranch_scc1 .Lpback
    s_and_b32 s12, s3, 63
    s_cselect_b32 s12, 0, 8192
    s_cmp_lg_u64 s[4:5], 0
    s_cselect_b64 exec, -1, 0
    s_add_u32 s13, s44, s12
    buffer_load_dwordx4 v[160:163], v0, s[40:43], s13 offen offset:0 sc1
    buffer_load_dwordx4 v[164:167], v0, s[40:43], s13 offen offset:1024 sc1
    s_cmp_lg_u64 s[6:7], 0
    s_cselect_b64 exec, -1, 0
    s_add_u32 s13, s45, s12
    buffer_load_dwordx4 v[168:171], v0, s[40:43], s13 offen offset:0 sc1
    buffer_load_dwordx4 v[172:175], v0, s[40:43], s13 offen offset:1024 sc1
    s_cmp_lg_u64 s[8:9], 0
    s_cselect_b64 exec, -1, 0
    s_add_u32 s13, s46, s12
    buffer_load_dwordx4 v[176:179], v0, s[40:43], s13 offen offset:0 sc1
    buffer_load_dwordx4 v[180:183], v0, s[40:43], s13 offen offset:1024 sc1
    s_cmp_lg_u64 s[10:11], 0
    s_cselect_b64 exec, -1, 0
    s_add_u32 s13, s47, s12
    buffer_load_dwordx4 v[184:187], v0, s[40:43], s13 offen offset:0 sc1
    buffer_load_dwordx4 v[188:191], v0, s[40:43], s13 offen offset:1024 sc1
    s_mov_b64 exec, -1
.Lpp:
    s_waitcnt vmcnt(6)
    v_xor_b32 v33, v160, v30
    v_xor_b32 v34, v162, v31
    v_bitop3_b32 v33, v33, v164, v30 bitop3:0xf6
    v_bitop3_b32 v34, v34, v166, v31 bitop3:0xf6
    v_bitop3_b32 v33, v33, v34, s54 bitop3:0xa8
    v_cmp_ne_u32 s[4:5], 0, v33
    s_waitcnt vmcnt(4)
    v_xor_b32 v33, v168, v30
    v_xor_b32 v34, v170, v31
    v_bitop3_b32 v33, v33, v172, v30 bitop3:0xf6
    v_bitop3_b32 v34, v34, v174, v31 bitop3:0xf6
    v_bitop3_b32 v33, v33, v34, s54 bitop3:0xa8
    v_cmp_ne_u32 s[6:7], 0, v33
    s_waitcnt vmcnt(2)
    v_xor_b32 v33, v176, v30
    v_xor_b32 v34, v178, v31
    v_bitop3_b32 v33, v33, v180, v30 bitop3:0xf6
    v_bitop3_b32 v34, v34, v182, v31 bitop3:0xf6
    v_bitop3_b32 v33, v33, v34, s54 bitop3:0xa8
    v_cmp_ne_u32 s[8:9], 0, v33
    s_waitcnt vmcnt(0)
    v_xor_b32 v33, v184, v30
    v_xor_b32 v34, v186, v31
    v_bitop3_b32 v33, v33, v188, v30 bitop3:0xf6
    v_bitop3_b32 v34, v34, v190, v31 bitop3:0xf6
    v_bitop3_b32 v33, v33, v34, s54 bitop3:0xa8
    v_cmp_ne_u32 s[10:11], 0, v33
    s_or_b64 s[12:13], s[4:5], s[6:7]
    s_or_b64 s[14:15], s[8:9], s[10:11]
    s_or_b64 s[12:13], s[12:13], s[14:15]
    s_cbranch_scc1 .Lpretry
.Lpback:
    v_mfma_f32_32x32x16_bf16 v[192:207], a[144:147], v[160:163], 0
    v_mfma_f32_32x32x16_bf16 v[192:207], a[148:151], v[164:167], v[192:207]
    v_mfma_f32_32x32x16_bf16 v[192:207], a[184:187], v[168:171], v[192:207]
    v_mfma_f32_32x32x16_bf16 v[192:207], a[188:191], v[172:175], v[192:207]
    v_mfma_f32_32x32x16_bf16 v[192:207], v[120:123], v[176:179], v[192:207]
    v_mfma_f32_32x32x16_bf16 v[192:207], v[124:127], v[180:183], v[192:207]
    v_mfma_f32_32x32x16_bf16 v[192:207], v[40:43], v[184:187], v[192:207]
    v_mfma_f32_32x32x16_bf16 v[192:207], v[44:47], v[188:191], v[192:207]
    v_mfma_f32_32x32x16_bf16 v[208:223], a[152:155], v[160:163], 0
    s_nop 4
    v_mfma_f32_32x32x16_bf16 v[208:223], a[156:159], v[164:167], v[208:223]
    s_nop 3
    v_mfma_f32_32x32x16_bf16 v[208:223], a[192:195], v[168:171], v[208:223]
    v_cvt_pk_bf16_f32 v192, v192, v193
    v_cvt_pk_bf16_f32 v193, v194, v195
    v_cvt_pk_bf16_f32 v194, v196, v197
    v_cvt_pk_bf16_f32 v195, v198, v199
    v_mfma_f32_32x32x16_bf16 v[208:223], a[196:199], v[172:175], v[208:223]
    v_bfi_b32 v192, s54, v30, v192
    v_bfi_b32 v194, s54, v31, v194
    buffer_store_dwordx4 v[192:195], v29, s[40:43], s52 offen offset:0 sc1
    v_mfma_f32_32x32x16_bf16 v[208:223], v[128:131], v[176:179], v[208:223]
    v_cvt_pk_bf16_f32 v196, v200, v201
    v_cvt_pk_bf16_f32 v197, v202, v203
    v_cvt_pk_bf16_f32 v198, v204, v205
    v_cvt_pk_bf16_f32 v199, v206, v207
    v_mfma_f32_32x32x16_bf16 v[208:223], v[132:135], v[180:183], v[208:223]
    v_bfi_b32 v196, s54, v30, v196
    v_bfi_b32 v198, s54, v31, v198
    buffer_store_dwordx4 v[196:199], v29, s[40:43], s53 offen offset:0 sc1
    v_mfma_f32_32x32x16_bf16 v[208:223], v[48:51], v[184:187], v[208:223]
    v_mfma_f32_32x32x16_bf16 v[208:223], v[52:55], v[188:191], v[208:223]
    v_mfma_f32_32x32x16_bf16 v[224:239], a[160:163], v[160:163], 0
    s_nop 4
    v_mfma_f32_32x32x16_bf16 v[224:239], a[164:167], v[164:167], v[224:239]
    s_nop 3
    v_mfma_f32_32x32x16_bf16 v[224:239], a[200:203], v[168:171], v[224:239]
    v_cvt_pk_bf16_f32 v208, v208, v209
    v_cvt_pk_bf16_f32 v209, v210, v211
    v_cvt_pk_bf16_f32 v210, v212, v213
    v_cvt_pk_bf16_f32 v211, v214, v215
    v_mfma_f32_32x32x16_bf16 v[224:239], a[204:207], v[172:175], v[224:239]
    v_bfi_b32 v208, s54, v30, v208
    v_bfi_b32 v210, s54, v31, v210
    buffer_store_dwordx4 v[208:211], v29, s[40:43], s52 offen offset:128 sc1
    v_mfma_f32_32x32x16_bf16 v[224:239], v[136:139], v[176:179], v[224:239]
    v_cvt_pk_bf16_f32 v212, v216, v217
    v_cvt_pk_bf16_f32 v213, v218, v219
    v_cvt_pk_bf16_f32 v214, v220, v221
    v_cvt_pk_bf16_f32 v215, v222, v223
    v_mfma_f32_32x32x16_bf16 v[224:239], v[140:143], v[180:183], v[224:239]
    v_bfi_b32 v212, s54, v30, v212
    v_bfi_b32 v214, s54, v31, v214
    buffer_store_dwordx4 v[212:215], v29, s[40:43], s53 offen offset:128 sc1
    v_mfma_f32_32x32x16_bf16 v[224:239], v[72:75], v[184:187], v[224:239]
    v_mfma_f32_32x32x16_bf16 v[224:239], v[76:79], v[188:191], v[224:239]
    v_mfma_f32_32x32x16_bf16 v[240:255], a[168:171], v[160:163], 0
    s_nop 4
    v_mfma_f32_32x32x16_bf16 v[240:255], a[172:175], v[164:167], v[240:255]
    s_nop 3
    v_mfma_f32_32x32x16_bf16 v[240:255], a[208:211], v[168:171], v[240:255]
    v_cvt_pk_bf16_f32 v224, v224, v225
    v_cvt_pk_bf16_f32 v225, v226, v227
    v_cvt_pk_bf16_f32 v226, v228, v229
    v_cvt_pk_bf16_f32 v227, v230, v231
    v_mfma_f32_32x32x16_bf16 v[240:255], a[212:215], v[172:175], v[240:255]
    v_bfi_b32 v224, s54, v30, v224
    v_bfi_b32 v226, s54, v31, v226
    buffer_store_dwordx4 v[224:227], v29, s[40:43], s52 offen offset:2048 sc1
    v_mfma_f32_32x32x16_bf16 v[240:255], v[144:147], v[176:179], v[240:255]
    s_mov_b64 exec, 1
    buffer_store_dword v32, off, s[40:43], s63 sc1
    s_mov_b64 exec, -1
    v_cvt_pk_bf16_f32 v228, v232, v233
    v_cvt_pk_bf16_f32 v229, v234, v235
    v_cvt_pk_bf16_f32 v230, v236, v237
    v_cvt_pk_bf16_f32 v231, v238, v239
    v_mfma_f32_32x32x16_bf16 v[240:255], v[148:151], v[180:183], v[240:255]
    v_bfi_b32 v228, s54, v30, v228
    v_bfi_b32 v230, s54, v31, v230
    buffer_store_dwordx4 v[228:231], v29, s[40:43], s53 offen offset:2048 sc1
    v_mfma_f32_32x32x16_bf16 v[240:255], v[88:91], v[184:187], v[240:255]
    v_mfma_f32_32x32x16_bf16 v[240:255], v[92:95], v[188:191], v[240:255]
    v_mfma_f32_32x32x16_bf16 v[56:71], a[176:179], v[160:163], 0
    s_nop 4
    v_mfma_f32_32x32x16_bf16 v[56:71], a[180:183], v[164:167], v[56:71]
    s_nop 3
    v_mfma_f32_32x32x16_bf16 v[56:71], a[216:219], v[168:171], v[56:71]
    v_cvt_pk_bf16_f32 v240, v240, v241
    v_cvt_pk_bf16_f32 v241, v242, v243
    v_cvt_pk_bf16_f32 v242, v244, v245
    v_cvt_pk_bf16_f32 v243, v246, v247
    v_mfma_f32_32x32x16_bf16 v[56:71], a[220:223], v[172:175], v[56:71]
    v_bfi_b32 v240, s54, v30, v240
    v_bfi_b32 v242, s54, v31, v242
    buffer_store_dwordx4 v[240:243], v29, s[40:43], s52 offen offset:2176 sc1
    v_mfma_f32_32x32x16_bf16 v[56:71], v[152:155], v[176:179], v[56:71]
    v_cvt_pk_bf16_f32 v244, v248, v249
    v_cvt_pk_bf16_f32 v245, v250, v251
    v_cvt_pk_bf16_f32 v246, v252, v253
    v_cvt_pk_bf16_f32 v247, v254, v255
    v_mfma_f32_32x32x16_bf16 v[56:71], v[156:159], v[180:183], v[56:71]
    v_bfi_b32 v244, s54, v30, v244
    v_bfi_b32 v246, s54, v31, v246
    buffer_store_dwordx4 v[244:247], v29, s[40:43], s53 offen offset:2176 sc1
    v_mfma_f32_32x32x16_bf16 v[56:71], v[104:107], v[184:187], v[56:71]
    v_mfma_f32_32x32x16_bf16 v[56:71], v[108:111], v[188:191], v[56:71]
    s_nop 11
    v_cvt_pk_bf16_f32 v56, v56, v57
    v_cvt_pk_bf16_f32 v57, v58, v59
    v_cvt_pk_bf16_f32 v58, v60, v61
    v_cvt_pk_bf16_f32 v59, v62, v63
    v_bfi_b32 v56, s54, v30, v56
    v_bfi_b32 v58, s54, v31, v58
    buffer_store_dwordx4 v[56:59], v1, s[40:43], s52 offen offset:0 sc1
    v_cvt_pk_bf16_f32 v60, v64, v65
    v_cvt_pk_bf16_f32 v61, v66, v67
    v_cvt_pk_bf16_f32 v62, v68, v69
    v_cvt_pk_bf16_f32 v63, v70, v71
    v_bfi_b32 v60, s54, v30, v60
    v_bfi_b32 v62, s54, v31, v62
    buffer_store_dwordx4 v[60:63], v1, s[40:43], s53 offen offset:0 sc1
    s_endpgm
.section .rodata,"a"
.p2align 6
.amdhsa_kernel standalone__mha_block_cached__near_ridge_kernel
  .amdhsa_next_free_vgpr 512
  .amdhsa_next_free_sgpr 102
  .amdhsa_accum_offset 256
  .amdhsa_group_segment_fixed_size 0
  .amdhsa_kernarg_size 64
  .amdhsa_user_sgpr_count 2
  .amdhsa_user_sgpr_kernarg_segment_ptr 1
  .amdhsa_system_sgpr_workgroup_id_x 1
.end_amdhsa_kernel
```
